```python
import torch

def _softmax(x, axis=-1):
    return torch.softmax(x, dim=axis)
def _gelu(x):
    return torch.nn.functional.gelu(x, approximate="tanh")
def _silu(x):
    return torch.nn.functional.silu(x)
def _sigmoid(x):
    return torch.sigmoid(x)
def _layernorm(x, axis=-1, eps=1e-5):
    m = x.mean(dim=axis, keepdim=True)
    v = x.var(dim=axis, keepdim=True, unbiased=False)
    return (x - m) / torch.sqrt(v + eps)
def _scatter_add(tgt, idx, src, axis=0):
    return tgt.clone().index_add_(axis, idx, src)
def _segment_sum(src, seg, n):
    out = torch.zeros((n,) + src.shape[1:], dtype=src.dtype)
    return out.index_add_(0, seg, src)
def _pad(x, pw):
    flat = tuple(v for pair in reversed(pw) for v in pair)
    return torch.nn.functional.pad(x, flat)

kernel_name = 'standalone__glu_gated_bilinear__prompt'

def setup_inputs():

    _w = (lambda a: (lambda t: t.to(torch.bfloat16) if t.is_floating_point() else t)(torch.as_tensor(a)))
    B, S, D, F = 1, 2048, 512, 1792
    return {
        "x": _w((lambda *s: torch.randn(*s, dtype=torch.bfloat16) * 0.05)(B, S, D)),
        "w_gate": _w((lambda *s: torch.randn(*s, dtype=torch.bfloat16) * 0.05)(D, F) * (D ** -0.5)),
        "w_up": _w((lambda *s: torch.randn(*s, dtype=torch.bfloat16) * 0.05)(D, F) * (D ** -0.5)),
        "w_down": _w((lambda *s: torch.randn(*s, dtype=torch.bfloat16) * 0.05)(F, D) * (F ** -0.5)),
    }

def reference(x, w_gate, w_up, w_down):
    g = torch.einsum("bsd,df->bsf", x, w_gate)
    u = torch.einsum("bsd,df->bsf", x, w_up)
    h = g * u
    return torch.einsum("bsf,fd->bsd", h, w_down)
```

```asm
; @launch grid=(256,1,1) block=(512,1,1) lds=163840
.amdgcn_target "amdgcn-amd-amdhsa--gfx950"
.text
.globl standalone__glu_gated_bilinear__prompt_kernel
.p2align 8
.type standalone__glu_gated_bilinear__prompt_kernel,@function
standalone__glu_gated_bilinear__prompt_kernel:

    s_load_dwordx2 s[8:9], s[0:1], 0
    s_load_dwordx2 s[12:13], s[0:1], 8
    s_load_dwordx2 s[16:17], s[0:1], 16
    s_cmp_ge_u32 s2, 256
    s_cbranch_scc1 L_end
    v_lshrrev_b32 v1, 6, v0
    v_and_b32 v2, 63, v0
    s_lshr_b32 s42, s2, 3
    v_readfirstlane_b32 s3, v1

    s_getpc_b64 s[4:5]
L_pcref:
    s_mul_i32 s44, s42, 768
    v_lshl_add_u32 v3, v0, 7, s44
    v_min_u32 v3, L_codeend-L_pcref, v3
    v_mov_b32 v29, s5
    v_add_co_u32 v28, vcc, s4, v3
    s_mov_b32 s10, 0x200000
    s_mov_b32 s11, 0x20000
    v_addc_co_u32 v29, vcc, 0, v29, vcc
    v_cmp_gt_u32 vcc, 6, v0
    s_and_saveexec_b64 s[6:7], vcc
    s_cbranch_execz L_nocode
    global_load_dword v31, v[28:29], off
L_nocode:
    s_mov_b64 exec, -1

    s_and_b32 s58, s2, 1
    s_bfe_u32 s59, s2, 0x10002
    s_bfe_u32 s55, s2, 0x10001
    s_lshl_b32 s46, s55, 2
    s_and_b32 s44, s42, 7
    s_lshr_b32 s45, s42, 3
    s_add_u32 s39, s44, s45
    s_add_u32 s47, s44, s46
    s_add_u32 s45, s45, s46
    s_cmp_ge_u32 s42, 24
    s_cselect_b32 s44, s47, s44
    s_cselect_b32 s45, 3, s45
    s_lshl_b32 s37, s58, 3
    s_add_u32 s37, s37, s44
    s_mul_i32 s38, s59, 7
    s_add_u32 s38, s38, s45
    s_and_b32 s39, s39, 1
    s_and_b32 s56, s2, 6
    s_lshl_b32 s44, s58, 2
    s_add_u32 s56, s56, s44
    s_add_u32 s39, s39, s56

    s_and_b32 s36, s3, 3

    s_mov_b32 s14, 0x1C0000
    s_mov_b32 s15, s11
    s_mov_b32 s18, s14
    s_mov_b32 s19, s11
    v_lshrrev_b32 v3, 3, v2
    v_and_b32 v4, 7, v2
    v_lshrrev_b32 v5, 4, v2
    s_lshl_b32 s44, s37, 2
    s_add_u32 s44, s44, s36
    s_lshl_b32 s44, s44, 15
    v_lshl_add_u32 v26, v3, 10, s44
    v_xor_b32 v27, v4, v5
    v_lshl_add_u32 v8, v27, 4, v26
    v_xor_b32 v9, 64, v8
    v_add_u32 v10, 14336, v8
    v_add_u32 v11, 21504, v9
    v_add_u32 v9, 7168, v9
    s_mul_i32 s45, s36, 57344
    s_lshl_b32 s44, s38, 8
    s_add_u32 s45, s45, s44
    v_mul_u32_u24 v26, 3584, v3
    v_add_u32 v26, s45, v26
    v_and_b32 v27, 2, v3
    v_xor_b32 v27, v4, v27
    v_lshl_add_u32 v12, v27, 4, v26
    v_xor_b32 v13, 64, v12
    v_add_u32 v13, 27648, v13
    s_lshl_b32 s51, s36, 12
    s_cmp_ge_u32 s3, 4
    s_cbranch_scc1 L_common
    s_cmp_ge_u32 s42, 28
    s_cbranch_scc1 L_common

    s_and_b32 s52, s39, 7
    s_lshl_b32 s53, s52, 7
    s_add_u32 m0, s51, 65536
    s_waitcnt lgkmcnt(0)
    buffer_load_dwordx4 v8, s[8:11], s53 offen offset:0  lds
    buffer_load_dwordx4 v9, s[8:11], s53 offen offset:1024  lds
    buffer_load_dwordx4 v10, s[8:11], s53 offen offset:2048  lds
    buffer_load_dwordx4 v11, s[8:11], s53 offen offset:3072  lds
    s_mul_i32 s54, s52, 229376
    s_add_u32 m0, s51, 81920
    s_nop 0
    buffer_load_dwordx4 v12, s[12:15], s54 offen offset:0  lds
    buffer_load_dwordx4 v13, s[12:15], s54 offen offset:1024  lds
    s_add_u32 m0, s51, 83968
    s_nop 0
    buffer_load_dwordx4 v12, s[16:19], s54 offen offset:0  lds
    buffer_load_dwordx4 v13, s[16:19], s54 offen offset:1024  lds
    s_add_u32 s52, s39, 1
    s_and_b32 s52, s52, 7
    s_lshl_b32 s53, s52, 7
    s_add_u32 m0, s51, 0
    s_nop 0
    buffer_load_dwordx4 v8, s[8:11], s53 offen offset:0  lds
    buffer_load_dwordx4 v9, s[8:11], s53 offen offset:1024  lds
L_common:

    s_load_dwordx2 s[20:21], s[0:1], 24
    s_load_dwordx2 s[24:25], s[0:1], 32
    s_load_dwordx2 s[28:29], s[0:1], 40
    s_load_dwordx2 s[32:33], s[0:1], 48
    s_mov_b32 s22, s14
    s_mov_b32 s23, s11
    s_mov_b32 s26, s10
    s_mov_b32 s27, s11
    s_movk_i32 s30, 0x100
    s_mov_b32 s31, s11
    s_mov_b32 s34, 0x10000000
    s_mov_b32 s35, s11
    s_mov_b32 s48, 200000
    s_lshl_b32 s40, s58, 2
    s_bfe_u32 s44, s2, 0x20001
    s_add_u32 s40, s40, s44
    s_lshl_b32 s40, s40, 2
    s_mul_i32 s44, s42, 57
    s_lshr_b32 s44, s44, 9
    s_add_u32 s44, s44, s42
    s_add_u32 s44, s44, 1
    s_sub_u32 s45, s42, 28
    s_mul_i32 s45, s45, 10
    s_cmp_lt_u32 s42, 28
    s_cselect_b32 s44, s44, s45
    s_and_b32 s41, s44, 7
    s_lshl_b32 s41, s41, 2
    s_lshr_b32 s41, 0x37261504, s41
    s_and_b32 s41, s41, 7
    s_lshr_b32 s44, s44, 3
    s_add_u32 s40, s40, s44
    s_cmp_ge_u32 s3, 4
    s_cbranch_scc1 L_C

    s_branch L_L
L_C_free:

    s_and_b32 s43, s2, 7
    s_waitcnt lgkmcnt(0)

    v_lshlrev_b32 v20, 7, v2
    s_cmp_lg_u32 s2, 248
    s_cbranch_scc1 L_noreset
    s_cmp_lg_u32 s3, 4
    s_cbranch_scc1 L_resetbar
    v_mov_b32 v16, 0
    v_mov_b32 v17, 0
    v_mov_b32 v18, 0
    v_mov_b32 v19, 0

    s_mov_b32 s47, 8388608
    buffer_store_dwordx4 v[16:19], v20, s[32:35], s47 offen sc1
    s_mov_b32 s47, 8396800
    buffer_store_dwordx4 v[16:19], v20, s[32:35], s47 offen sc1
    s_mov_b32 s47, 8404992
    buffer_store_dwordx4 v[16:19], v20, s[32:35], s47 offen sc1
    s_mov_b32 s47, 8413184
    buffer_store_dwordx4 v[16:19], v20, s[32:35], s47 offen sc1

    s_waitcnt vmcnt(0)
    v_mov_b32 v7, 1
    s_mov_b64 exec, 1
    buffer_store_dword v7, off, s[28:31], 0 sc1
    s_mov_b64 exec, -1

L_resetbar:
    s_barrier
L_noreset:

    s_sub_u32 s49, s42, 28
    s_lshl_b32 s49, s49, 2
    s_add_u32 s49, s49, s36
    s_lshl_b32 s50, s49, 3
    s_add_u32 s50, s50, s43
    v_mul_u32_u24 v21, 3584, v2

    s_setprio 1
    s_lshr_b32 s44, s49, 3
    s_mul_i32 s44, s44, 1
    s_add_u32 s44, s44, 2
    s_add_u32 s44, s44, s56
    s_and_b32 s44, s44, 7
    s_mul_i32 s44, s44, 229376
    s_and_b32 s45, s49, 3
    s_mul_i32 s46, s55, 3
    s_add_u32 s45, s45, s46
    s_mul_i32 s46, s59, 7
    s_add_u32 s45, s45, s46
    s_lshl_b32 s45, s45, 8
    s_add_u32 s44, s44, s45
    s_bitcmp1_b32 s49, 2
    s_cbranch_scc1 L_pu_23
    buffer_load_dword v32, v21, s[12:15], s44 offen offset:0
    s_branch L_pe_24
L_pu_23:
    buffer_load_dword v33, v21, s[16:19], s44 offen offset:0
L_pe_24:
    s_lshr_b32 s44, s49, 3
    s_mul_i32 s44, s44, 1
    s_add_u32 s44, s44, 0
    s_add_u32 s44, s44, s56
    s_and_b32 s44, s44, 7
    s_mul_i32 s44, s44, 229376
    s_and_b32 s45, s49, 3
    s_mul_i32 s46, s55, 3
    s_add_u32 s45, s45, s46
    s_mul_i32 s46, s59, 7
    s_add_u32 s45, s45, s46
    s_lshl_b32 s45, s45, 8
    s_add_u32 s44, s44, s45
    s_bitcmp1_b32 s49, 2
    s_cbranch_scc1 L_pu_25
    buffer_load_dword v34, v21, s[12:15], s44 offen offset:128
    s_branch L_pe_26
L_pu_25:
    buffer_load_dword v35, v21, s[16:19], s44 offen offset:128
L_pe_26:
    s_lshr_b32 s44, s49, 3
    s_mul_i32 s44, s44, 1
    s_add_u32 s44, s44, 2
    s_add_u32 s44, s44, s56
    s_and_b32 s44, s44, 7
    s_mul_i32 s44, s44, 229376
    s_and_b32 s45, s49, 3
    s_mul_i32 s46, s55, 3
    s_add_u32 s45, s45, s46
    s_mul_i32 s46, s59, 7
    s_add_u32 s45, s45, s46
    s_lshl_b32 s45, s45, 8
    s_add_u32 s44, s44, s45
    s_bitcmp1_b32 s49, 2
    s_cbranch_scc1 L_pu_27
    buffer_load_dword v36, v21, s[12:15], s44 offen offset:128
    s_branch L_pe_28
L_pu_27:
    buffer_load_dword v37, v21, s[16:19], s44 offen offset:128
L_pe_28:
    s_cmp_ge_u32 s50, 112
    s_cbranch_scc1 L_pe_29
    s_lshr_b32 s45, s50, 3
    s_lshl_b32 s45, s45, 17
    s_and_b32 s46, s50, 7
    s_lshl_b32 s46, s46, 13
    s_add_u32 s45, s45, s46
    buffer_load_dword v38, v20, s[20:23], s45 offen offset:0
L_pe_29:
    s_cmp_ge_u32 s50, 112
    s_cbranch_scc1 L_pe_30
    s_lshr_b32 s45, s50, 3
    s_lshl_b32 s45, s45, 17
    s_and_b32 s46, s50, 7
    s_lshl_b32 s46, s46, 13
    s_add_u32 s45, s45, s46
    s_add_u32 s45, s45, 0x10000
    buffer_load_dword v39, v20, s[20:23], s45 offen offset:0
L_pe_30:
    v_lshlrev_b32 v24, 10, v2
    s_cmp_ge_u32 s49, 14
    s_cbranch_scc1 L_pe_31
    s_lshl_b32 s45, s49, 17
    s_add_u32 s45, s45, 0
    buffer_load_dword v40, v24, s[20:23], s45 offen offset:384
L_pe_31:
    s_setprio 0
    v_lshlrev_b32 v24, 10, v2
    s_cmp_ge_u32 s49, 14
    s_cbranch_scc1 L_pe_32
    s_lshl_b32 s45, s49, 17
    s_add_u32 s45, s45, 65536
    buffer_load_dword v41, v24, s[20:23], s45 offen offset:384
L_pe_32:
    s_waitcnt vmcnt(0)
L_final:

    s_lshr_b32 s44, s3, 2
    s_lshl_b32 s44, s44, 15
    s_lshl_b32 s45, s36, 11
    s_add_u32 s44, s44, s45
    s_add_u32 s44, s44, 65536
    v_lshl_add_u32 v8, v3, 8, s44
    v_lshlrev_b32 v9, 1, v4
    v_xor_b32 v9, v9, v3
    v_lshl_add_u32 v8, v9, 4, v8
    v_xor_b32 v9, 16, v8
    s_lshl_b32 s44, s40, 6
    s_lshl_b32 s45, s3, 3
    s_add_u32 s44, s44, s45
    s_lshl_b32 s44, s44, 10
    s_lshl_b32 s45, s41, 7
    s_add_u32 s44, s44, s45
    v_lshlrev_b32 v10, 10, v3
    v_lshl_add_u32 v10, v4, 4, v10
    s_waitcnt lgkmcnt(0)

    s_barrier
    ds_read_b128 v[32:35], v8 offset:0
    ds_read_b128 v[36:39], v9 offset:0
    ds_read_b128 v[40:43], v8 offset:8192
    ds_read_b128 v[44:47], v9 offset:8192
    ds_read_b128 v[48:51], v8 offset:16384
    ds_read_b128 v[52:55], v9 offset:16384
    ds_read_b128 v[56:59], v8 offset:24576
    ds_read_b128 v[60:63], v9 offset:24576
    s_waitcnt lgkmcnt(4)
    v_pk_add_f32 v[32:33], v[32:33], v[40:41]
    v_pk_add_f32 v[34:35], v[34:35], v[42:43]
    v_pk_add_f32 v[36:37], v[36:37], v[44:45]
    v_pk_add_f32 v[38:39], v[38:39], v[46:47]
    s_waitcnt lgkmcnt(2)
    v_pk_add_f32 v[32:33], v[32:33], v[48:49]
    v_pk_add_f32 v[34:35], v[34:35], v[50:51]
    v_pk_add_f32 v[36:37], v[36:37], v[52:53]
    v_pk_add_f32 v[38:39], v[38:39], v[54:55]
    s_waitcnt lgkmcnt(0)
    v_pk_add_f32 v[32:33], v[32:33], v[56:57]
    v_pk_add_f32 v[34:35], v[34:35], v[58:59]
    v_pk_add_f32 v[36:37], v[36:37], v[60:61]
    v_pk_add_f32 v[38:39], v[38:39], v[62:63]
    v_cvt_pk_bf16_f32 v12, v32, v33
    v_cvt_pk_bf16_f32 v13, v34, v35
    v_cvt_pk_bf16_f32 v14, v36, v37
    v_cvt_pk_bf16_f32 v15, v38, v39
    buffer_store_dwordx4 v[12:15], v10, s[24:27], s44 offen sc1
L_end:
    s_endpgm
.p2align 12
L_L:

    s_lshl_b32 s45, s41, 7
    v_lshl_add_u32 v30, v3, 10, s45
    v_lshlrev_b32 v1, 1, v5
    v_xor_b32 v1, v4, v1
    v_lshl_add_u32 v14, v1, 4, v30
    v_add_u32 v15, 7168, v14
    v_add_u32 v16, 14336, v14
    v_add_u32 v17, 21504, v14
    s_lshr_b32 s44, s40, 3
    s_mul_i32 s44, s44, 1835008
    s_and_b32 s45, s40, 7
    s_lshl_b32 s45, s45, 12
    s_add_u32 s44, s44, s45
    v_lshl_add_u32 v18, v2, 4, s44

    s_lshr_b32 s44, s40, 1
    s_mul_i32 s44, s44, 14
    s_mul_i32 s45, s36, 14
    s_lshr_b32 s45, s45, 2
    s_add_u32 s44, s44, s45
    s_lshl_b32 s44, s44, 7
    s_and_b32 s45, s40, 1
    s_lshl_b32 s45, s45, 3
    s_add_u32 s44, s44, s45
    s_add_u32 s44, s44, 8388608
    v_bfe_u32 v30, v2, 1, 2
    v_lshlrev_b32 v30, 7, v30
    v_and_b32 v1, 1, v2
    v_lshl_add_u32 v30, v1, 2, v30
    v_add_u32 v19, s44, v30
    s_lshl_b32 s50, s36, 13
    s_add_u32 s50, s50, 65536
    v_lshrrev_b32 v30, 2, v2
    v_lshl_add_u32 v30, v30, 7, s50
    v_and_b32 v1, 3, v2
    v_lshl_add_u32 v30, v1, 3, v30
    v_and_b32 v1, 3, v3
    v_lshl_add_u32 v22, v1, 5, v30
    v_xor_b32 v23, 32, v22
    v_xor_b32 v24, 64, v22
    v_xor_b32 v25, 96, v22
    v_add_u32 v26, 0x10000, v22
    v_add_u32 v27, 0x10000, v23
    v_add_u32 v28, 0x10000, v24
    v_add_u32 v29, 0x10000, v25
    v_and_b32 v30, 15, v2
    v_lshl_add_u32 v30, v30, 8, s50
    v_xor_b32 v1, v4, v5
    v_lshl_add_u32 v6, v1, 4, v30
    v_xor_b32 v7, 64, v6
    v_mov_b32 v20, 0

    s_lshr_b32 s44, s36, 1
    s_mul_i32 s44, s44, 917504
    s_bitcmp1_b32 s36, 0
    s_mov_b32 s60, 0
    s_cmov_b32 s60, 524288
    s_mov_b32 s61, 131072
    s_cmov_b32 s61, 655360
    s_mov_b32 s62, 262144
    s_cmov_b32 s62, 786432
    s_mov_b32 s63, 393216
    s_cmov_b32 s63, 425984
    s_mov_b32 s64, 32768
    s_cmov_b32 s64, 557056
    s_mov_b32 s65, 163840
    s_cmov_b32 s65, 688128
    s_mov_b32 s66, 294912
    s_cmov_b32 s66, 819200
    s_add_u32 s60, s60, s44
    s_add_u32 s61, s61, s44
    s_add_u32 s62, s62, s44
    s_add_u32 s63, s63, s44
    s_add_u32 s64, s64, s44
    s_add_u32 s65, s65, s44
    s_add_u32 s66, s66, s44
    s_waitcnt lgkmcnt(0)

    s_cmp_lg_u32 s2, 248
    s_cbranch_scc1 L_L_nb
    s_barrier
L_L_nb:
    s_cmp_lt_u32 s42, 28
    s_cbranch_scc1 L_pp_2
    s_waitcnt vmcnt(0)
    s_branch L_np_1
L_pp_2:
    s_waitcnt vmcnt(9)
    buffer_load_dwordx4 v10, s[8:11], s53 offen offset:2048  lds
    s_waitcnt vmcnt(9)
    buffer_load_dwordx4 v11, s[8:11], s53 offen offset:3072  lds
    s_mul_i32 s54, s52, 229376
    s_add_u32 m0, s51, 16384
    s_waitcnt vmcnt(9)
    buffer_load_dwordx4 v12, s[12:15], s54 offen offset:0  lds
    s_waitcnt vmcnt(9)
    buffer_load_dwordx4 v13, s[12:15], s54 offen offset:1024  lds
    s_add_u32 m0, s51, 18432
    s_waitcnt vmcnt(9)
    buffer_load_dwordx4 v12, s[16:19], s54 offen offset:0  lds
    s_waitcnt vmcnt(9)
    buffer_load_dwordx4 v13, s[16:19], s54 offen offset:1024  lds
    s_add_u32 s52, s39, 2
    s_and_b32 s52, s52, 7
    s_lshl_b32 s53, s52, 7
    s_add_u32 m0, s51, 32768
    s_waitcnt vmcnt(9)
    buffer_load_dwordx4 v8, s[8:11], s53 offen offset:0  lds
    s_waitcnt vmcnt(9)
    s_barrier
    buffer_load_dwordx4 v9, s[8:11], s53 offen offset:1024  lds
    s_waitcnt vmcnt(9)
    buffer_load_dwordx4 v10, s[8:11], s53 offen offset:2048  lds
    s_waitcnt vmcnt(9)
    buffer_load_dwordx4 v11, s[8:11], s53 offen offset:3072  lds
    s_mul_i32 s54, s52, 229376
    s_add_u32 m0, s51, 49152
    s_waitcnt vmcnt(9)
    buffer_load_dwordx4 v12, s[12:15], s54 offen offset:0  lds
    s_waitcnt vmcnt(9)
    buffer_load_dwordx4 v13, s[12:15], s54 offen offset:1024  lds
    s_add_u32 m0, s51, 51200
    s_waitcnt vmcnt(9)
    buffer_load_dwordx4 v12, s[16:19], s54 offen offset:0  lds
    s_waitcnt vmcnt(9)
    buffer_load_dwordx4 v13, s[16:19], s54 offen offset:1024  lds
    s_add_u32 s52, s39, 3
    s_and_b32 s52, s52, 7
    s_lshl_b32 s53, s52, 7
    s_add_u32 m0, s51, 98304
    s_waitcnt vmcnt(9)
    buffer_load_dwordx4 v8, s[8:11], s53 offen offset:0  lds
    s_waitcnt vmcnt(9)
    s_barrier
    buffer_load_dwordx4 v9, s[8:11], s53 offen offset:1024  lds
    s_waitcnt vmcnt(9)
    buffer_load_dwordx4 v10, s[8:11], s53 offen offset:2048  lds
    s_waitcnt vmcnt(9)
    buffer_load_dwordx4 v11, s[8:11], s53 offen offset:3072  lds
    s_add_u32 s52, s39, 4
    s_and_b32 s52, s52, 7
    s_lshl_b32 s53, s52, 7
    s_add_u32 m0, s51, 114688
    s_waitcnt vmcnt(9)
    buffer_load_dwordx4 v8, s[8:11], s53 offen offset:0  lds
    s_waitcnt vmcnt(9)
    buffer_load_dwordx4 v9, s[8:11], s53 offen offset:1024  lds
    s_waitcnt vmcnt(9)
    buffer_load_dwordx4 v10, s[8:11], s53 offen offset:2048  lds
    s_waitcnt vmcnt(9)
    buffer_load_dwordx4 v11, s[8:11], s53 offen offset:3072  lds
    s_add_u32 s52, s39, 5
    s_and_b32 s52, s52, 7
    s_lshl_b32 s53, s52, 7
    s_add_u32 m0, s51, 131072
    s_waitcnt vmcnt(9)
    buffer_load_dwordx4 v8, s[8:11], s53 offen offset:0  lds
    s_waitcnt vmcnt(9)
    s_barrier
    buffer_load_dwordx4 v9, s[8:11], s53 offen offset:1024  lds
    s_waitcnt vmcnt(9)
    buffer_load_dwordx4 v10, s[8:11], s53 offen offset:2048  lds
    s_waitcnt vmcnt(9)
    buffer_load_dwordx4 v11, s[8:11], s53 offen offset:3072  lds
    s_add_u32 s52, s39, 6
    s_and_b32 s52, s52, 7
    s_lshl_b32 s53, s52, 7
    s_add_u32 m0, s51, 147456
    s_waitcnt vmcnt(9)
    buffer_load_dwordx4 v8, s[8:11], s53 offen offset:0  lds
    s_waitcnt vmcnt(9)
    buffer_load_dwordx4 v9, s[8:11], s53 offen offset:1024  lds
    s_waitcnt vmcnt(9)
    buffer_load_dwordx4 v10, s[8:11], s53 offen offset:2048  lds
    s_waitcnt vmcnt(9)
    buffer_load_dwordx4 v11, s[8:11], s53 offen offset:3072  lds
    s_add_u32 s52, s39, 3
    s_and_b32 s52, s52, 7
    s_mul_i32 s54, s52, 229376
    s_add_u32 m0, s51, 65536
    s_waitcnt vmcnt(9)
    buffer_load_dwordx4 v12, s[12:15], s54 offen offset:0  lds
    s_waitcnt vmcnt(9)
    s_barrier
    buffer_load_dwordx4 v13, s[12:15], s54 offen offset:1024  lds
    s_add_u32 m0, s51, 67584
    s_waitcnt vmcnt(9)
    buffer_load_dwordx4 v12, s[16:19], s54 offen offset:0  lds
    s_waitcnt vmcnt(9)
    buffer_load_dwordx4 v13, s[16:19], s54 offen offset:1024  lds
    s_add_u32 s52, s39, 7
    s_and_b32 s52, s52, 7
    s_lshl_b32 s53, s52, 7
    s_add_u32 m0, s51, 81920
    s_waitcnt vmcnt(9)
    buffer_load_dwordx4 v8, s[8:11], s53 offen offset:0  lds
    s_waitcnt vmcnt(9)
    buffer_load_dwordx4 v9, s[8:11], s53 offen offset:1024  lds
    s_waitcnt vmcnt(9)
    buffer_load_dwordx4 v10, s[8:11], s53 offen offset:2048  lds
    s_waitcnt vmcnt(9)
    buffer_load_dwordx4 v11, s[8:11], s53 offen offset:3072  lds
    s_add_u32 s52, s39, 4
    s_and_b32 s52, s52, 7
    s_mul_i32 s54, s52, 229376
    s_add_u32 m0, s51, 0
    s_waitcnt vmcnt(9)
    buffer_load_dwordx4 v12, s[12:15], s54 offen offset:0  lds
    s_waitcnt vmcnt(9)
    s_barrier
    buffer_load_dwordx4 v13, s[12:15], s54 offen offset:1024  lds
    s_add_u32 m0, s51, 2048
    s_waitcnt vmcnt(9)
    buffer_load_dwordx4 v12, s[16:19], s54 offen offset:0  lds
    s_waitcnt vmcnt(9)
    buffer_load_dwordx4 v13, s[16:19], s54 offen offset:1024  lds
    s_add_u32 s52, s39, 5
    s_and_b32 s52, s52, 7
    s_mul_i32 s54, s52, 229376
    s_add_u32 m0, s51, 16384
    s_waitcnt vmcnt(9)
    buffer_load_dwordx4 v12, s[12:15], s54 offen offset:0  lds
    s_waitcnt vmcnt(9)
    buffer_load_dwordx4 v13, s[12:15], s54 offen offset:1024  lds
    s_add_u32 m0, s51, 18432
    s_waitcnt vmcnt(9)
    buffer_load_dwordx4 v12, s[16:19], s54 offen offset:0  lds
    s_waitcnt vmcnt(9)
    buffer_load_dwordx4 v13, s[16:19], s54 offen offset:1024  lds
    s_waitcnt vmcnt(8)
    s_barrier
    s_add_u32 s52, s39, 6
    s_and_b32 s52, s52, 7
    s_mul_i32 s54, s52, 229376
    s_add_u32 m0, s51, 32768
    s_nop 0
    buffer_load_dwordx4 v12, s[12:15], s54 offen offset:0  lds
    buffer_load_dwordx4 v13, s[12:15], s54 offen offset:1024  lds
    s_add_u32 m0, s51, 34816
    s_waitcnt vmcnt(9)
    buffer_load_dwordx4 v12, s[16:19], s54 offen offset:0  lds
    s_waitcnt vmcnt(9)
    buffer_load_dwordx4 v13, s[16:19], s54 offen offset:1024  lds
    s_add_u32 s52, s39, 7
    s_and_b32 s52, s52, 7
    s_mul_i32 s54, s52, 229376
    s_add_u32 m0, s51, 49152
    s_waitcnt vmcnt(9)
    buffer_load_dwordx4 v12, s[12:15], s54 offen offset:0  lds
    s_waitcnt vmcnt(9)
    buffer_load_dwordx4 v13, s[12:15], s54 offen offset:1024  lds
    s_add_u32 m0, s51, 51200
    s_waitcnt vmcnt(9)
    buffer_load_dwordx4 v12, s[16:19], s54 offen offset:0  lds
    s_waitcnt vmcnt(9)
    buffer_load_dwordx4 v13, s[16:19], s54 offen offset:1024  lds
    s_add_u32 s52, s39, 0
    s_and_b32 s52, s52, 7
    s_mul_i32 s54, s52, 229376
    s_add_u32 s54, s54, 128
    s_add_u32 m0, s51, 98304
    s_waitcnt vmcnt(9)
    buffer_load_dwordx4 v12, s[12:15], s54 offen offset:0  lds
    s_waitcnt vmcnt(9)
    s_barrier
    buffer_load_dword v20, off, s[28:31], 0 sc1
    s_waitcnt vmcnt(9)
    buffer_load_dwordx4 v13, s[12:15], s54 offen offset:1024  lds
    s_add_u32 m0, s51, 100352
    s_waitcnt vmcnt(9)
    buffer_load_dwordx4 v12, s[16:19], s54 offen offset:0  lds
    s_waitcnt vmcnt(9)
    buffer_load_dwordx4 v13, s[16:19], s54 offen offset:1024  lds
    s_add_u32 s52, s39, 1
    s_and_b32 s52, s52, 7
    s_mul_i32 s54, s52, 229376
    s_add_u32 s54, s54, 128
    s_add_u32 m0, s51, 114688
    s_waitcnt vmcnt(9)
    buffer_load_dwordx4 v12, s[12:15], s54 offen offset:0  lds
    s_waitcnt vmcnt(9)
    buffer_load_dwordx4 v13, s[12:15], s54 offen offset:1024  lds
    s_add_u32 m0, s51, 116736
    s_waitcnt vmcnt(9)
    buffer_load_dwordx4 v12, s[16:19], s54 offen offset:0  lds
    s_waitcnt vmcnt(9)
    buffer_load_dwordx4 v13, s[16:19], s54 offen offset:1024  lds
    s_add_u32 s52, s39, 2
    s_and_b32 s52, s52, 7
    s_mul_i32 s54, s52, 229376
    s_add_u32 s54, s54, 128
    s_add_u32 m0, s51, 131072
    s_waitcnt vmcnt(9)
    buffer_load_dwordx4 v12, s[12:15], s54 offen offset:0  lds
L_np_1:
    s_cmp_lt_u32 s42, 28
    s_cbranch_scc1 L_pp_4
    s_waitcnt vmcnt(0)
    s_branch L_np_3
L_pp_4:
    s_barrier
    s_add_u32 m0, s51, 131072
    s_waitcnt vmcnt(9)
    buffer_load_dwordx4 v13, s[12:15], s54 offen offset:1024  lds
    s_add_u32 m0, s51, 133120
    s_waitcnt vmcnt(9)
    buffer_load_dwordx4 v12, s[16:19], s54 offen offset:0  lds
    s_waitcnt vmcnt(9)
    buffer_load_dwordx4 v13, s[16:19], s54 offen offset:1024  lds
    s_add_u32 s52, s39, 3
    s_and_b32 s52, s52, 7
    s_mul_i32 s54, s52, 229376
    s_add_u32 s54, s54, 128
    s_add_u32 m0, s51, 147456
    s_waitcnt vmcnt(9)
    buffer_load_dwordx4 v12, s[12:15], s54 offen offset:0  lds
    s_waitcnt vmcnt(9)
    buffer_load_dwordx4 v13, s[12:15], s54 offen offset:1024  lds
    s_add_u32 m0, s51, 149504
    s_waitcnt vmcnt(9)
    buffer_load_dwordx4 v12, s[16:19], s54 offen offset:0  lds
    s_waitcnt vmcnt(9)
    buffer_load_dwordx4 v13, s[16:19], s54 offen offset:1024  lds
L_np_3:
    s_add_u32 m0, s50, 0
    s_waitcnt vmcnt(9)
    buffer_load_dwordx4 v14, s[20:23], s60 offen offset:0  lds
    s_waitcnt vmcnt(9)
    buffer_load_dwordx4 v15, s[20:23], s60 offen offset:1024  lds
    s_cmp_lt_u32 s42, 28
    s_cbranch_scc1 L_pp_6
    s_waitcnt vmcnt(0)
    s_branch L_np_5
L_pp_6:
    s_barrier
L_np_5:
    s_add_u32 m0, s50, 0
    s_waitcnt vmcnt(9)
    buffer_load_dwordx4 v16, s[20:23], s60 offen offset:2048  lds
    s_waitcnt vmcnt(9)
    buffer_load_dwordx4 v17, s[20:23], s60 offen offset:3072  lds
    s_cmp_lt_u32 s42, 28
    s_cbranch_scc1 L_pp_8
    s_waitcnt vmcnt(0)
    s_branch L_np_7
L_pp_8:
    s_add_u32 s52, s39, 4
    s_and_b32 s52, s52, 7
    s_mul_i32 s54, s52, 229376
    s_add_u32 s54, s54, 128
    s_add_u32 m0, s51, 0
    s_waitcnt vmcnt(9)
    buffer_load_dwordx4 v12, s[12:15], s54 offen offset:0  lds
    s_waitcnt vmcnt(9)
    buffer_load_dwordx4 v13, s[12:15], s54 offen offset:1024  lds
    s_add_u32 m0, s51, 2048
    s_waitcnt vmcnt(9)
    buffer_load_dwordx4 v12, s[16:19], s54 offen offset:0  lds
    s_waitcnt vmcnt(9)
    buffer_load_dwordx4 v13, s[16:19], s54 offen offset:1024  lds
    s_add_u32 s52, s39, 5
    s_and_b32 s52, s52, 7
L_stub4:
    s_cbranch_execz L_warmed
    s_mul_i32 s54, s52, 229376
    s_add_u32 s54, s54, 128
    s_add_u32 m0, s51, 16384
    s_waitcnt vmcnt(9)
    buffer_load_dwordx4 v12, s[12:15], s54 offen offset:0  lds
    s_waitcnt vmcnt(9)
    buffer_load_dwordx4 v13, s[12:15], s54 offen offset:1024  lds
    s_add_u32 m0, s51, 18432
    s_waitcnt vmcnt(9)
    buffer_load_dwordx4 v12, s[16:19], s54 offen offset:0  lds
    s_waitcnt vmcnt(9)
    buffer_load_dwordx4 v13, s[16:19], s54 offen offset:1024  lds
L_np_7:
    s_add_u32 m0, s50, 4096
    s_waitcnt vmcnt(9)
    buffer_load_dwordx4 v14, s[20:23], s61 offen offset:0  lds
    s_waitcnt vmcnt(9)
    buffer_load_dwordx4 v15, s[20:23], s61 offen offset:1024  lds
    s_waitcnt vmcnt(9)
    buffer_load_dwordx4 v16, s[20:23], s61 offen offset:2048  lds
    s_waitcnt vmcnt(9)
    buffer_load_dwordx4 v17, s[20:23], s61 offen offset:3072  lds
    s_cmp_lt_u32 s42, 28
    s_cbranch_scc1 L_pp_10
    s_waitcnt vmcnt(0)
    s_branch L_np_9
L_pp_10:
    v_cmp_eq_u32 vcc, 0, v20
    s_cbranch_vccz L_gok_11
L_gsp_12:
    buffer_load_dword v20, off, s[28:31], 0 sc1
    s_cmp_eq_u32 s48, 0
    s_cbranch_scc1 L_gok_11
    s_sub_u32 s48, s48, 1
    s_waitcnt vmcnt(0)
    v_cmp_eq_u32 vcc, 0, v20
    s_cbranch_vccnz L_gsp_12
L_gok_11:
    s_barrier
    s_add_u32 s52, s39, 6
    s_and_b32 s52, s52, 7
    s_mul_i32 s54, s52, 229376
    s_add_u32 s54, s54, 128
    s_add_u32 m0, s51, 32768
    s_waitcnt vmcnt(9)
    buffer_load_dwordx4 v12, s[12:15], s54 offen offset:0  lds
    s_waitcnt vmcnt(9)
    buffer_load_dwordx4 v13, s[12:15], s54 offen offset:1024  lds
    s_add_u32 m0, s51, 34816
    s_waitcnt vmcnt(9)
    buffer_load_dwordx4 v12, s[16:19], s54 offen offset:0  lds
    s_waitcnt vmcnt(9)
    buffer_load_dwordx4 v13, s[16:19], s54 offen offset:1024  lds
    s_add_u32 s52, s39, 7
    s_and_b32 s52, s52, 7
    s_mul_i32 s54, s52, 229376
    s_add_u32 s54, s54, 128
    s_add_u32 m0, s51, 49152
    s_waitcnt vmcnt(9)
    buffer_load_dwordx4 v12, s[12:15], s54 offen offset:0  lds
    s_waitcnt vmcnt(9)
    buffer_load_dwordx4 v13, s[12:15], s54 offen offset:1024  lds
    s_add_u32 m0, s51, 51200
    s_waitcnt vmcnt(9)
    buffer_load_dwordx4 v12, s[16:19], s54 offen offset:0  lds
    s_waitcnt vmcnt(9)
    buffer_load_dwordx4 v13, s[16:19], s54 offen offset:1024  lds
L_np_9:
    s_setprio 3
    ds_read_b64_tr_b16 v[32:33], v22 offset:0
    ds_read_b64_tr_b16 v[34:35], v22 offset:2048
    ds_read_b64_tr_b16 v[36:37], v23 offset:0
    ds_read_b64_tr_b16 v[38:39], v23 offset:2048
    ds_read_b64_tr_b16 v[40:41], v24 offset:0
    ds_read_b64_tr_b16 v[42:43], v24 offset:2048
    ds_read_b64_tr_b16 v[44:45], v25 offset:0
    ds_read_b64_tr_b16 v[46:47], v25 offset:2048
    s_setprio 0
    s_waitcnt lgkmcnt(0)
    s_add_u32 m0, s50, 0
    s_waitcnt vmcnt(9)
    buffer_load_dwordx4 v14, s[20:23], s62 offen offset:0  lds
    s_waitcnt vmcnt(9)
    s_setprio 3
    ds_read_b64_tr_b16 v[48:49], v22 offset:4096
    ds_read_b64_tr_b16 v[50:51], v22 offset:6144
    s_setprio 0
    buffer_load_dwordx4 v15, s[20:23], s62 offen offset:1024  lds
    s_setprio 3
    ds_read_b64_tr_b16 v[52:53], v23 offset:4096
    ds_read_b64_tr_b16 v[54:55], v23 offset:6144
    s_setprio 0
    s_waitcnt vmcnt(9)
    buffer_load_dwordx4 v16, s[20:23], s62 offen offset:2048  lds
    s_setprio 3
    ds_read_b64_tr_b16 v[56:57], v24 offset:4096
    ds_read_b64_tr_b16 v[58:59], v24 offset:6144
    s_setprio 0
    s_waitcnt vmcnt(9)
    buffer_load_dwordx4 v17, s[20:23], s62 offen offset:3072  lds
    s_setprio 3
    ds_read_b64_tr_b16 v[60:61], v25 offset:4096
    ds_read_b64_tr_b16 v[62:63], v25 offset:6144
    s_setprio 0
    s_waitcnt lgkmcnt(0)
    s_add_u32 m0, s50, 4096
    s_waitcnt vmcnt(9)
    buffer_load_dwordx4 v14, s[20:23], s63 offen offset:0  lds
    s_waitcnt vmcnt(9)
    buffer_load_dwordx4 v15, s[20:23], s63 offen offset:1024  lds
    s_waitcnt vmcnt(9)
    buffer_load_dwordx4 v16, s[20:23], s63 offen offset:2048  lds
    s_cmp_lt_u32 s42, 28
    s_cbranch_scc1 L_pp_14
    s_waitcnt vmcnt(0)
    s_branch L_np_13
L_pp_14:
    s_waitcnt vmcnt(7)
    s_barrier
L_np_13:
    s_add_u32 m0, s50, 4096
    s_nop 0
    buffer_load_dwordx4 v17, s[20:23], s63 offen offset:3072  lds
    s_add_u32 m0, s50, 32768
    s_nop 0
    buffer_load_dwordx4 v14, s[20:23], s64 offen offset:0  lds
    buffer_load_dwordx4 v15, s[20:23], s64 offen offset:1024  lds
    s_waitcnt vmcnt(9)
    buffer_load_dwordx4 v16, s[20:23], s64 offen offset:2048  lds
    s_waitcnt vmcnt(9)
    buffer_load_dwordx4 v17, s[20:23], s64 offen offset:3072  lds
    s_add_u32 m0, s50, 36864
    s_waitcnt vmcnt(9)
    buffer_load_dwordx4 v14, s[20:23], s65 offen offset:0  lds
    s_waitcnt vmcnt(9)
    s_setprio 3
    ds_read_b64_tr_b16 v[128:129], v22 offset:0
    ds_read_b64_tr_b16 v[130:131], v22 offset:2048
    s_setprio 0
    buffer_load_dwordx4 v15, s[20:23], s65 offen offset:1024  lds
    s_setprio 3
    ds_read_b64_tr_b16 v[132:133], v23 offset:0
    ds_read_b64_tr_b16 v[134:135], v23 offset:2048
    s_setprio 0
    s_waitcnt vmcnt(9)
    buffer_load_dwordx4 v16, s[20:23], s65 offen offset:2048  lds
    s_setprio 3
    ds_read_b64_tr_b16 v[136:137], v24 offset:0
    ds_read_b64_tr_b16 v[138:139], v24 offset:2048
    s_setprio 0
    s_waitcnt vmcnt(9)
    buffer_load_dwordx4 v17, s[20:23], s65 offen offset:3072  lds
    s_setprio 3
    ds_read_b64_tr_b16 v[140:141], v25 offset:0
    ds_read_b64_tr_b16 v[142:143], v25 offset:2048
    s_setprio 0
    s_waitcnt lgkmcnt(0)
    s_add_u32 m0, s50, 0
    s_waitcnt vmcnt(9)
    buffer_load_dwordx4 v14, s[20:23], s66 offen offset:0  lds
    s_waitcnt vmcnt(9)
    s_setprio 3
    ds_read_b64_tr_b16 v[144:145], v22 offset:4096
    ds_read_b64_tr_b16 v[146:147], v22 offset:6144
    s_setprio 0
    buffer_load_dwordx4 v15, s[20:23], s66 offen offset:1024  lds
    s_setprio 3
    ds_read_b64_tr_b16 v[148:149], v23 offset:4096
    ds_read_b64_tr_b16 v[150:151], v23 offset:6144
    s_setprio 0
    s_waitcnt vmcnt(9)
    buffer_load_dwordx4 v16, s[20:23], s66 offen offset:2048  lds
    s_setprio 3
    ds_read_b64_tr_b16 v[152:153], v24 offset:4096
    ds_read_b64_tr_b16 v[154:155], v24 offset:6144
    s_setprio 0
    s_waitcnt vmcnt(9)
    buffer_load_dwordx4 v17, s[20:23], s66 offen offset:3072  lds
    s_setprio 3
    ds_read_b64_tr_b16 v[156:157], v25 offset:4096
    ds_read_b64_tr_b16 v[158:159], v25 offset:6144
    s_setprio 0
    v_cmp_eq_u32 vcc, 0, v20
    s_cbranch_vccz L_gok_15
L_gsp_16:
    buffer_load_dword v20, off, s[28:31], 0 sc1
    s_cmp_eq_u32 s48, 0
    s_cbranch_scc1 L_gok_15
    s_sub_u32 s48, s48, 1
    s_waitcnt vmcnt(0)
    v_cmp_eq_u32 vcc, 0, v20
    s_cbranch_vccnz L_gsp_16
L_gok_15:
    buffer_load_dword v21, v19, s[32:35], 0 offen sc1
    v_add_u32 v14, 0x10000, v14
    v_add_u32 v15, 0x10000, v15
    v_add_u32 v16, 0x10000, v16
    v_add_u32 v17, 0x10000, v17
    s_waitcnt lgkmcnt(0)
    s_add_u32 m0, s50, 4096
    s_waitcnt vmcnt(9)
    buffer_load_dwordx4 v14, s[20:23], s60 offen offset:0  lds
    s_setprio 3
    ds_read_b64_tr_b16 v[160:161], v22 offset:32768
    ds_read_b64_tr_b16 v[162:163], v22 offset:34816
    s_setprio 0
    s_waitcnt vmcnt(9)
    buffer_load_dwordx4 v15, s[20:23], s60 offen offset:1024  lds
    s_setprio 3
    ds_read_b64_tr_b16 v[164:165], v23 offset:32768
    ds_read_b64_tr_b16 v[166:167], v23 offset:34816
    s_setprio 0
    s_waitcnt vmcnt(9)
    buffer_load_dwordx4 v16, s[20:23], s60 offen offset:2048  lds
    s_setprio 3
    ds_read_b64_tr_b16 v[168:169], v24 offset:32768
    ds_read_b64_tr_b16 v[170:171], v24 offset:34816
    s_setprio 0
    s_waitcnt vmcnt(9)
    buffer_load_dwordx4 v17, s[20:23], s60 offen offset:3072  lds
    s_setprio 3
    ds_read_b64_tr_b16 v[172:173], v25 offset:32768
    ds_read_b64_tr_b16 v[174:175], v25 offset:34816
    s_setprio 0
    s_waitcnt vmcnt(4)
    v_cmp_gt_u32 vcc, 1, v21
    s_cbranch_vccz L_fok_17
L_fsp_18:
    buffer_load_dword v21, v19, s[32:35], 0 offen sc1
    s_cmp_eq_u32 s48, 0
    s_cbranch_scc1 L_fok_17
    s_sub_u32 s48, s48, 1
    s_waitcnt vmcnt(0)
    v_cmp_gt_u32 vcc, 1, v21
    s_cbranch_vccnz L_fsp_18
L_fok_17:
    buffer_load_dwordx4 v[176:179], v18, s[32:35], s60 offen offset:0 sc1
    s_setprio 3
    ds_read_b64_tr_b16 v[180:181], v22 offset:36864
    ds_read_b64_tr_b16 v[182:183], v22 offset:38912
    s_setprio 0
    buffer_load_dwordx4 v[184:187], v18, s[32:35], s60 offen offset:1024 sc1
    s_setprio 3
    ds_read_b64_tr_b16 v[188:189], v23 offset:36864
    ds_read_b64_tr_b16 v[190:191], v23 offset:38912
    s_setprio 0
    buffer_load_dwordx4 v[192:195], v18, s[32:35], s60 offen offset:2048 sc1
    s_setprio 3
    ds_read_b64_tr_b16 v[196:197], v24 offset:36864
    ds_read_b64_tr_b16 v[198:199], v24 offset:38912
    s_setprio 0
    buffer_load_dwordx4 v[200:203], v18, s[32:35], s60 offen offset:3072 sc1
    s_setprio 3
    ds_read_b64_tr_b16 v[204:205], v25 offset:36864
    ds_read_b64_tr_b16 v[206:207], v25 offset:38912
    s_setprio 0
    buffer_load_dwordx4 v[208:211], v18, s[32:35], s61 offen offset:0 sc1
    s_setprio 3
    ds_read_b64_tr_b16 v[212:213], v22 offset:0
    ds_read_b64_tr_b16 v[214:215], v22 offset:2048
    s_setprio 0
    buffer_load_dwordx4 v[216:219], v18, s[32:35], s61 offen offset:1024 sc1
    s_setprio 3
    ds_read_b64_tr_b16 v[220:221], v23 offset:0
    ds_read_b64_tr_b16 v[222:223], v23 offset:2048
    s_setprio 0
    s_waitcnt vmcnt(9)
    buffer_load_dwordx4 v[224:227], v18, s[32:35], s61 offen offset:2048 sc1
    s_setprio 3
    ds_read_b64_tr_b16 v[228:229], v24 offset:0
    ds_read_b64_tr_b16 v[230:231], v24 offset:2048
    s_setprio 0
    s_waitcnt vmcnt(9)
    buffer_load_dwordx4 v[232:235], v18, s[32:35], s61 offen offset:3072 sc1
    s_setprio 3
    ds_read_b64_tr_b16 v[236:237], v25 offset:0
    ds_read_b64_tr_b16 v[238:239], v25 offset:2048
    s_setprio 0
    s_waitcnt vmcnt(9)
    buffer_load_dwordx4 v[240:243], v18, s[32:35], s62 offen offset:0 sc1
    s_waitcnt vmcnt(9)
    buffer_load_dwordx4 v[244:247], v18, s[32:35], s62 offen offset:1024 sc1
    s_waitcnt vmcnt(9)
    buffer_load_dwordx4 v[248:251], v18, s[32:35], s62 offen offset:2048 sc1
    s_waitcnt vmcnt(9)
    buffer_load_dwordx4 v[252:255], v18, s[32:35], s62 offen offset:3072 sc1
    v_mfma_f32_16x16x32_bf16 v[64:67], v[32:35], v[176:179], 0
    s_waitcnt vmcnt(9)
    buffer_load_dwordx4 v[8:11], v18, s[32:35], s63 offen offset:0 sc1
    v_mfma_f32_16x16x32_bf16 v[68:71], v[36:39], v[176:179], 0
    v_mfma_f32_16x16x32_bf16 v[72:75], v[40:43], v[176:179], 0
    v_mfma_f32_16x16x32_bf16 v[76:79], v[44:47], v[176:179], 0
    v_mfma_f32_16x16x32_bf16 v[92:95], v[44:47], v[184:187], 0
    s_waitcnt vmcnt(9)
    buffer_load_dwordx4 v[176:179], v18, s[32:35], s63 offen offset:1024 sc1
    v_mfma_f32_16x16x32_bf16 v[88:91], v[40:43], v[184:187], 0
    v_mfma_f32_16x16x32_bf16 v[84:87], v[36:39], v[184:187], 0
    v_mfma_f32_16x16x32_bf16 v[80:83], v[32:35], v[184:187], 0
    v_mfma_f32_16x16x32_bf16 v[96:99], v[32:35], v[192:195], 0
    s_waitcnt vmcnt(9)
    buffer_load_dwordx4 v[184:187], v18, s[32:35], s63 offen offset:2048 sc1
    v_mfma_f32_16x16x32_bf16 v[100:103], v[36:39], v[192:195], 0
    v_mfma_f32_16x16x32_bf16 v[104:107], v[40:43], v[192:195], 0
    v_mfma_f32_16x16x32_bf16 v[108:111], v[44:47], v[192:195], 0
    v_mfma_f32_16x16x32_bf16 v[124:127], v[44:47], v[200:203], 0
    s_waitcnt vmcnt(9)
    buffer_load_dwordx4 v[192:195], v18, s[32:35], s63 offen offset:3072 sc1
    v_mfma_f32_16x16x32_bf16 v[120:123], v[40:43], v[200:203], 0
    v_mfma_f32_16x16x32_bf16 v[116:119], v[36:39], v[200:203], 0
    v_mfma_f32_16x16x32_bf16 v[112:115], v[32:35], v[200:203], 0
    v_mfma_f32_16x16x32_bf16 v[64:67], v[48:51], v[208:211], v[64:67]
    s_waitcnt vmcnt(9)
    buffer_load_dwordx4 v[44:47], v18, s[32:35], s64 offen offset:0 sc1
    v_mfma_f32_16x16x32_bf16 v[68:71], v[52:55], v[208:211], v[68:71]
    v_mfma_f32_16x16x32_bf16 v[72:75], v[56:59], v[208:211], v[72:75]
    v_mfma_f32_16x16x32_bf16 v[76:79], v[60:63], v[208:211], v[76:79]
    v_mfma_f32_16x16x32_bf16 v[92:95], v[60:63], v[216:219], v[92:95]
    s_waitcnt vmcnt(9)
    buffer_load_dwordx4 v[40:43], v18, s[32:35], s64 offen offset:1024 sc1
    v_mfma_f32_16x16x32_bf16 v[88:91], v[56:59], v[216:219], v[88:91]
    v_mfma_f32_16x16x32_bf16 v[84:87], v[52:55], v[216:219], v[84:87]
    v_mfma_f32_16x16x32_bf16 v[80:83], v[48:51], v[216:219], v[80:83]
    v_mfma_f32_16x16x32_bf16 v[96:99], v[48:51], v[224:227], v[96:99]
    s_waitcnt vmcnt(9)
    buffer_load_dwordx4 v[36:39], v18, s[32:35], s64 offen offset:2048 sc1
    v_mfma_f32_16x16x32_bf16 v[100:103], v[52:55], v[224:227], v[100:103]
    v_mfma_f32_16x16x32_bf16 v[104:107], v[56:59], v[224:227], v[104:107]
    v_mfma_f32_16x16x32_bf16 v[108:111], v[60:63], v[224:227], v[108:111]
    v_mfma_f32_16x16x32_bf16 v[124:127], v[60:63], v[232:235], v[124:127]
    s_waitcnt vmcnt(9)
    buffer_load_dwordx4 v[200:203], v18, s[32:35], s64 offen offset:3072 sc1
    v_mfma_f32_16x16x32_bf16 v[120:123], v[56:59], v[232:235], v[120:123]
    v_mfma_f32_16x16x32_bf16 v[116:119], v[52:55], v[232:235], v[116:119]
    v_mfma_f32_16x16x32_bf16 v[112:115], v[48:51], v[232:235], v[112:115]
    v_mfma_f32_16x16x32_bf16 v[64:67], v[128:131], v[240:243], v[64:67]
    s_waitcnt vmcnt(9)
    buffer_load_dwordx4 v[32:35], v18, s[32:35], s65 offen offset:0 sc1
    v_mfma_f32_16x16x32_bf16 v[68:71], v[132:135], v[240:243], v[68:71]
    s_waitcnt vmcnt(9)
    buffer_load_dwordx4 v[208:211], v18, s[32:35], s65 offen offset:1024 sc1
    v_mfma_f32_16x16x32_bf16 v[72:75], v[136:139], v[240:243], v[72:75]
    s_waitcnt vmcnt(9)
    buffer_load_dwordx4 v[216:219], v18, s[32:35], s65 offen offset:2048 sc1
L_stub5:
    s_cbranch_execz L_warmed
    v_mfma_f32_16x16x32_bf16 v[76:79], v[140:143], v[240:243], v[76:79]
    v_mfma_f32_16x16x32_bf16 v[92:95], v[140:143], v[244:247], v[92:95]
    s_waitcnt vmcnt(9)
    buffer_load_dwordx4 v[224:227], v18, s[32:35], s65 offen offset:3072 sc1
    v_mfma_f32_16x16x32_bf16 v[88:91], v[136:139], v[244:247], v[88:91]
    ds_read_b64_tr_b16 v[60:61], v22 offset:4096
    v_mfma_f32_16x16x32_bf16 v[84:87], v[132:135], v[244:247], v[84:87]
    ds_read_b64_tr_b16 v[62:63], v22 offset:6144
    v_mfma_f32_16x16x32_bf16 v[80:83], v[128:131], v[244:247], v[80:83]
    v_mfma_f32_16x16x32_bf16 v[96:99], v[128:131], v[248:251], v[96:99]
    ds_read_b64_tr_b16 v[56:57], v23 offset:4096
    v_mfma_f32_16x16x32_bf16 v[100:103], v[132:135], v[248:251], v[100:103]
    ds_read_b64_tr_b16 v[58:59], v23 offset:6144
    v_mfma_f32_16x16x32_bf16 v[104:107], v[136:139], v[248:251], v[104:107]
    ds_read_b64_tr_b16 v[52:53], v24 offset:4096
    v_mfma_f32_16x16x32_bf16 v[108:111], v[140:143], v[248:251], v[108:111]
    v_mfma_f32_16x16x32_bf16 v[124:127], v[140:143], v[252:255], v[124:127]
    ds_read_b64_tr_b16 v[54:55], v24 offset:6144
    v_mfma_f32_16x16x32_bf16 v[120:123], v[136:139], v[252:255], v[120:123]
    ds_read_b64_tr_b16 v[232:233], v25 offset:4096
    v_mfma_f32_16x16x32_bf16 v[116:119], v[132:135], v[252:255], v[116:119]
    ds_read_b64_tr_b16 v[234:235], v25 offset:6144
    v_mfma_f32_16x16x32_bf16 v[112:115], v[128:131], v[252:255], v[112:115]
    v_mfma_f32_16x16x32_bf16 v[64:67], v[144:147], v[8:11], v[64:67]
    s_waitcnt vmcnt(9)
    buffer_load_dwordx4 v[48:51], v18, s[32:35], s66 offen offset:0 sc1
    v_mfma_f32_16x16x32_bf16 v[68:71], v[148:151], v[8:11], v[68:71]
    v_mfma_f32_16x16x32_bf16 v[72:75], v[152:155], v[8:11], v[72:75]
    v_mfma_f32_16x16x32_bf16 v[76:79], v[156:159], v[8:11], v[76:79]
    v_mfma_f32_16x16x32_bf16 v[92:95], v[156:159], v[176:179], v[92:95]
    s_waitcnt vmcnt(9)
    buffer_load_dwordx4 v[240:243], v18, s[32:35], s66 offen offset:1024 sc1
    v_mfma_f32_16x16x32_bf16 v[88:91], v[152:155], v[176:179], v[88:91]
    v_mfma_f32_16x16x32_bf16 v[84:87], v[148:151], v[176:179], v[84:87]
    v_mfma_f32_16x16x32_bf16 v[80:83], v[144:147], v[176:179], v[80:83]
    v_mfma_f32_16x16x32_bf16 v[96:99], v[144:147], v[184:187], v[96:99]
    s_waitcnt vmcnt(9)
    buffer_load_dwordx4 v[244:247], v18, s[32:35], s66 offen offset:2048 sc1
    v_mfma_f32_16x16x32_bf16 v[100:103], v[148:151], v[184:187], v[100:103]
    v_mfma_f32_16x16x32_bf16 v[104:107], v[152:155], v[184:187], v[104:107]
    v_mfma_f32_16x16x32_bf16 v[108:111], v[156:159], v[184:187], v[108:111]
    v_mfma_f32_16x16x32_bf16 v[124:127], v[156:159], v[192:195], v[124:127]
    s_waitcnt vmcnt(9)
    buffer_load_dwordx4 v[248:251], v18, s[32:35], s66 offen offset:3072 sc1
    v_mfma_f32_16x16x32_bf16 v[120:123], v[152:155], v[192:195], v[120:123]
    v_mfma_f32_16x16x32_bf16 v[116:119], v[148:151], v[192:195], v[116:119]
    v_mfma_f32_16x16x32_bf16 v[112:115], v[144:147], v[192:195], v[112:115]
    s_waitcnt lgkmcnt(15)
    v_mfma_f32_16x16x32_bf16 v[64:67], v[160:163], v[44:47], v[64:67]
    s_add_u32 m0, s50, 32768
    s_waitcnt vmcnt(9)
    buffer_load_dwordx4 v14, s[20:23], s61 offen offset:0  lds
    v_mfma_f32_16x16x32_bf16 v[68:71], v[164:167], v[44:47], v[68:71]
    v_mfma_f32_16x16x32_bf16 v[72:75], v[168:171], v[44:47], v[72:75]
    s_waitcnt vmcnt(9)
    buffer_load_dwordx4 v15, s[20:23], s61 offen offset:1024  lds
    v_mfma_f32_16x16x32_bf16 v[76:79], v[172:175], v[44:47], v[76:79]
    v_mfma_f32_16x16x32_bf16 v[92:95], v[172:175], v[40:43], v[92:95]
    s_waitcnt vmcnt(9)
    buffer_load_dwordx4 v16, s[20:23], s61 offen offset:2048  lds
    v_mfma_f32_16x16x32_bf16 v[88:91], v[168:171], v[40:43], v[88:91]
    v_mfma_f32_16x16x32_bf16 v[84:87], v[164:167], v[40:43], v[84:87]
    s_waitcnt vmcnt(9)
    buffer_load_dwordx4 v17, s[20:23], s61 offen offset:3072  lds
    v_mfma_f32_16x16x32_bf16 v[80:83], v[160:163], v[40:43], v[80:83]
    v_mfma_f32_16x16x32_bf16 v[96:99], v[160:163], v[36:39], v[96:99]
    s_add_u32 m0, s50, 36864
    s_waitcnt vmcnt(9)
    buffer_load_dwordx4 v14, s[20:23], s62 offen offset:0  lds
    v_mfma_f32_16x16x32_bf16 v[100:103], v[164:167], v[36:39], v[100:103]
    v_mfma_f32_16x16x32_bf16 v[104:107], v[168:171], v[36:39], v[104:107]
    s_waitcnt vmcnt(9)
    buffer_load_dwordx4 v15, s[20:23], s62 offen offset:1024  lds
    v_mfma_f32_16x16x32_bf16 v[108:111], v[172:175], v[36:39], v[108:111]
    v_mfma_f32_16x16x32_bf16 v[124:127], v[172:175], v[200:203], v[124:127]
    s_waitcnt vmcnt(9)
    buffer_load_dwordx4 v16, s[20:23], s62 offen offset:2048  lds
    v_mfma_f32_16x16x32_bf16 v[120:123], v[168:171], v[200:203], v[120:123]
    v_mfma_f32_16x16x32_bf16 v[116:119], v[164:167], v[200:203], v[116:119]
    s_waitcnt vmcnt(9)
    buffer_load_dwordx4 v17, s[20:23], s62 offen offset:3072  lds
    v_mfma_f32_16x16x32_bf16 v[112:115], v[160:163], v[200:203], v[112:115]
    v_mfma_f32_16x16x32_bf16 v[64:67], v[180:183], v[32:35], v[64:67]
    s_waitcnt lgkmcnt(8)
    s_add_u32 m0, s50, 0
    s_waitcnt vmcnt(9)
    buffer_load_dwordx4 v14, s[20:23], s63 offen offset:0  lds
    v_mfma_f32_16x16x32_bf16 v[68:71], v[188:191], v[32:35], v[68:71]
    s_waitcnt vmcnt(9)
    buffer_load_dwordx4 v15, s[20:23], s63 offen offset:1024  lds
    v_mfma_f32_16x16x32_bf16 v[72:75], v[196:199], v[32:35], v[72:75]
    s_waitcnt vmcnt(9)
    buffer_load_dwordx4 v16, s[20:23], s63 offen offset:2048  lds
    v_mfma_f32_16x16x32_bf16 v[76:79], v[204:207], v[32:35], v[76:79]
    s_waitcnt vmcnt(9)
    buffer_load_dwordx4 v17, s[20:23], s63 offen offset:3072  lds
    v_mfma_f32_16x16x32_bf16 v[92:95], v[204:207], v[208:211], v[92:95]
    s_waitcnt lgkmcnt(0)
    s_add_u32 m0, s50, 4096
    s_waitcnt vmcnt(9)
    buffer_load_dwordx4 v14, s[20:23], s64 offen offset:0  lds
    v_mfma_f32_16x16x32_bf16 v[88:91], v[196:199], v[208:211], v[88:91]
    s_waitcnt vmcnt(9)
    buffer_load_dwordx4 v15, s[20:23], s64 offen offset:1024  lds
    v_mfma_f32_16x16x32_bf16 v[84:87], v[188:191], v[208:211], v[84:87]
    ds_read_b64_tr_b16 v[140:141], v22 offset:32768
    v_mfma_f32_16x16x32_bf16 v[80:83], v[180:183], v[208:211], v[80:83]
    ds_read_b64_tr_b16 v[142:143], v22 offset:34816
    v_mfma_f32_16x16x32_bf16 v[96:99], v[180:183], v[216:219], v[96:99]
    ds_read_b64_tr_b16 v[136:137], v23 offset:32768
    v_mfma_f32_16x16x32_bf16 v[100:103], v[188:191], v[216:219], v[100:103]
    ds_read_b64_tr_b16 v[138:139], v23 offset:34816
    v_mfma_f32_16x16x32_bf16 v[104:107], v[196:199], v[216:219], v[104:107]
    ds_read_b64_tr_b16 v[132:133], v24 offset:32768
    v_mfma_f32_16x16x32_bf16 v[108:111], v[204:207], v[216:219], v[108:111]
    ds_read_b64_tr_b16 v[134:135], v24 offset:34816
    v_mfma_f32_16x16x32_bf16 v[124:127], v[204:207], v[224:227], v[124:127]
    ds_read_b64_tr_b16 v[252:253], v25 offset:32768
    v_mfma_f32_16x16x32_bf16 v[120:123], v[196:199], v[224:227], v[120:123]
    ds_read_b64_tr_b16 v[254:255], v25 offset:34816
    v_mfma_f32_16x16x32_bf16 v[116:119], v[188:191], v[224:227], v[116:119]
    s_waitcnt vmcnt(9)
    buffer_load_dwordx4 v16, s[20:23], s64 offen offset:2048  lds
    v_mfma_f32_16x16x32_bf16 v[112:115], v[180:183], v[224:227], v[112:115]
    s_waitcnt vmcnt(9)
    buffer_load_dwordx4 v17, s[20:23], s64 offen offset:3072  lds
    v_mfma_f32_16x16x32_bf16 v[64:67], v[212:215], v[48:51], v[64:67]
    buffer_load_dword v21, v19, s[32:35], 0 offen sc1
    s_waitcnt lgkmcnt(0)
    s_add_u32 m0, s50, 32768
    s_waitcnt vmcnt(9)
    buffer_load_dwordx4 v14, s[20:23], s65 offen offset:0  lds
    v_mfma_f32_16x16x32_bf16 v[68:71], v[220:223], v[48:51], v[68:71]
    s_waitcnt vmcnt(9)
    buffer_load_dwordx4 v15, s[20:23], s65 offen offset:1024  lds
    ds_read_b64_tr_b16 v[128:129], v22 offset:36864
    v_mfma_f32_16x16x32_bf16 v[72:75], v[228:231], v[48:51], v[72:75]
    ds_read_b64_tr_b16 v[130:131], v22 offset:38912
    v_mfma_f32_16x16x32_bf16 v[76:79], v[236:239], v[48:51], v[76:79]
    ds_read_b64_tr_b16 v[8:9], v23 offset:36864
    ds_read_b64_tr_b16 v[10:11], v23 offset:38912
    v_mfma_f32_16x16x32_bf16 v[92:95], v[236:239], v[240:243], v[92:95]
    ds_read_b64_tr_b16 v[176:177], v24 offset:36864
    v_mfma_f32_16x16x32_bf16 v[88:91], v[228:231], v[240:243], v[88:91]
    ds_read_b64_tr_b16 v[178:179], v24 offset:38912
    ds_read_b64_tr_b16 v[184:185], v25 offset:36864
    v_mfma_f32_16x16x32_bf16 v[84:87], v[220:223], v[240:243], v[84:87]
    ds_read_b64_tr_b16 v[186:187], v25 offset:38912
    v_mfma_f32_16x16x32_bf16 v[80:83], v[212:215], v[240:243], v[80:83]
    s_waitcnt vmcnt(9)
    buffer_load_dwordx4 v16, s[20:23], s65 offen offset:2048  lds
    s_waitcnt vmcnt(9)
    buffer_load_dwordx4 v17, s[20:23], s65 offen offset:3072  lds
    v_mfma_f32_16x16x32_bf16 v[96:99], v[212:215], v[244:247], v[96:99]
    s_waitcnt lgkmcnt(0)
    s_add_u32 m0, s50, 36864
    s_waitcnt vmcnt(9)
    buffer_load_dwordx4 v14, s[20:23], s66 offen offset:0  lds
    s_waitcnt vmcnt(9)
    buffer_load_dwordx4 v15, s[20:23], s66 offen offset:1024  lds
    v_mfma_f32_16x16x32_bf16 v[100:103], v[220:223], v[244:247], v[100:103]
    ds_read_b64_tr_b16 v[156:157], v22 offset:0
    v_mfma_f32_16x16x32_bf16 v[104:107], v[228:231], v[244:247], v[104:107]
    ds_read_b64_tr_b16 v[158:159], v22 offset:2048
    ds_read_b64_tr_b16 v[152:153], v23 offset:0
    v_mfma_f32_16x16x32_bf16 v[108:111], v[236:239], v[244:247], v[108:111]
    ds_read_b64_tr_b16 v[154:155], v23 offset:2048
    v_mfma_f32_16x16x32_bf16 v[124:127], v[236:239], v[248:251], v[124:127]
    ds_read_b64_tr_b16 v[148:149], v24 offset:0
    ds_read_b64_tr_b16 v[150:151], v24 offset:2048
    v_mfma_f32_16x16x32_bf16 v[120:123], v[228:231], v[248:251], v[120:123]
    ds_read_b64_tr_b16 v[192:193], v25 offset:0
    v_mfma_f32_16x16x32_bf16 v[116:119], v[220:223], v[248:251], v[116:119]
    ds_read_b64_tr_b16 v[194:195], v25 offset:2048
    s_waitcnt vmcnt(9)
    buffer_load_dwordx4 v16, s[20:23], s66 offen offset:2048  lds
    v_mfma_f32_16x16x32_bf16 v[112:115], v[212:215], v[248:251], v[112:115]
    s_waitcnt vmcnt(9)
    buffer_load_dwordx4 v17, s[20:23], s66 offen offset:3072  lds
    s_waitcnt vmcnt(8)
    v_cmp_gt_u32 vcc, 2, v21
    s_cbranch_vccz L_fok_19
L_fsp_20:
    buffer_load_dword v21, v19, s[32:35], 0 offen sc1
    s_cmp_eq_u32 s48, 0
    s_cbranch_scc1 L_fok_19
    s_sub_u32 s48, s48, 1
    s_waitcnt vmcnt(0)
    v_cmp_gt_u32 vcc, 2, v21
    s_cbranch_vccnz L_fsp_20
L_fok_19:
    v_add_u32 v18, 0x10000, v18
    buffer_load_dwordx4 v[144:147], v18, s[32:35], s60 offen offset:0 sc1
    buffer_load_dwordx4 v[44:47], v18, s[32:35], s60 offen offset:1024 sc1
    s_waitcnt vmcnt(9)
    buffer_load_dwordx4 v[40:43], v18, s[32:35], s60 offen offset:2048 sc1
    s_waitcnt vmcnt(9)
    buffer_load_dwordx4 v[36:39], v18, s[32:35], s60 offen offset:3072 sc1
    ds_read_b64_tr_b16 v[172:173], v22 offset:4096
    ds_read_b64_tr_b16 v[174:175], v22 offset:6144
    ds_read_b64_tr_b16 v[168:169], v23 offset:4096
    ds_read_b64_tr_b16 v[170:171], v23 offset:6144
    ds_read_b64_tr_b16 v[164:165], v24 offset:4096
    ds_read_b64_tr_b16 v[166:167], v24 offset:6144
    ds_read_b64_tr_b16 v[200:201], v25 offset:4096
    ds_read_b64_tr_b16 v[202:203], v25 offset:6144
    s_waitcnt vmcnt(9)
    buffer_load_dwordx4 v[160:163], v18, s[32:35], s61 offen offset:0 sc1
    s_waitcnt vmcnt(9)
    buffer_load_dwordx4 v[32:35], v18, s[32:35], s61 offen offset:1024 sc1
    s_waitcnt vmcnt(9)
    buffer_load_dwordx4 v[208:211], v18, s[32:35], s61 offen offset:2048 sc1
    s_waitcnt vmcnt(9)
    buffer_load_dwordx4 v[216:219], v18, s[32:35], s61 offen offset:3072 sc1
    ds_read_b64_tr_b16 v[204:205], v22 offset:32768
    ds_read_b64_tr_b16 v[206:207], v22 offset:34816
    ds_read_b64_tr_b16 v[196:197], v23 offset:32768
    ds_read_b64_tr_b16 v[198:199], v23 offset:34816
    ds_read_b64_tr_b16 v[188:189], v24 offset:32768
    ds_read_b64_tr_b16 v[190:191], v24 offset:34816
    ds_read_b64_tr_b16 v[224:225], v25 offset:32768
    ds_read_b64_tr_b16 v[226:227], v25 offset:34816
    s_waitcnt vmcnt(9)
    buffer_load_dwordx4 v[180:183], v18, s[32:35], s62 offen offset:0 sc1
    s_waitcnt vmcnt(9)
    buffer_load_dwordx4 v[48:51], v18, s[32:35], s62 offen offset:1024 sc1
    s_waitcnt vmcnt(9)
    buffer_load_dwordx4 v[240:243], v18, s[32:35], s62 offen offset:2048 sc1
    s_waitcnt vmcnt(9)
    buffer_load_dwordx4 v[244:247], v18, s[32:35], s62 offen offset:3072 sc1
    v_cmp_gt_u32 vcc, 3, v21
    s_cbranch_vccz L_fok_21
L_fsp_22:
    buffer_load_dword v21, v19, s[32:35], 0 offen sc1
    s_cmp_eq_u32 s48, 0
    s_cbranch_scc1 L_fok_21
    s_sub_u32 s48, s48, 1
    s_waitcnt vmcnt(0)
    v_cmp_gt_u32 vcc, 3, v21
    s_cbranch_vccnz L_fsp_22
L_fok_21:
    v_mfma_f32_16x16x32_bf16 v[64:67], v[60:63], v[144:147], v[64:67]
    s_waitcnt vmcnt(9)
    buffer_load_dwordx4 v[236:239], v18, s[32:35], s63 offen offset:0 sc1
    v_mfma_f32_16x16x32_bf16 v[68:71], v[56:59], v[144:147], v[68:71]
    v_mfma_f32_16x16x32_bf16 v[72:75], v[52:55], v[144:147], v[72:75]
    v_mfma_f32_16x16x32_bf16 v[76:79], v[232:235], v[144:147], v[76:79]
    v_mfma_f32_16x16x32_bf16 v[92:95], v[232:235], v[44:47], v[92:95]
    s_waitcnt vmcnt(9)
    buffer_load_dwordx4 v[228:231], v18, s[32:35], s63 offen offset:1024 sc1
    v_mfma_f32_16x16x32_bf16 v[88:91], v[52:55], v[44:47], v[88:91]
    v_mfma_f32_16x16x32_bf16 v[84:87], v[56:59], v[44:47], v[84:87]
    v_mfma_f32_16x16x32_bf16 v[80:83], v[60:63], v[44:47], v[80:83]
    v_mfma_f32_16x16x32_bf16 v[96:99], v[60:63], v[40:43], v[96:99]
    s_waitcnt vmcnt(9)
    buffer_load_dwordx4 v[220:223], v18, s[32:35], s63 offen offset:2048 sc1
    v_mfma_f32_16x16x32_bf16 v[100:103], v[56:59], v[40:43], v[100:103]
    v_mfma_f32_16x16x32_bf16 v[104:107], v[52:55], v[40:43], v[104:107]
    v_mfma_f32_16x16x32_bf16 v[108:111], v[232:235], v[40:43], v[108:111]
    v_mfma_f32_16x16x32_bf16 v[124:127], v[232:235], v[36:39], v[124:127]
    s_waitcnt vmcnt(9)
    buffer_load_dwordx4 v[248:251], v18, s[32:35], s63 offen offset:3072 sc1
    v_mfma_f32_16x16x32_bf16 v[120:123], v[52:55], v[36:39], v[120:123]
    v_mfma_f32_16x16x32_bf16 v[116:119], v[56:59], v[36:39], v[116:119]
    v_mfma_f32_16x16x32_bf16 v[112:115], v[60:63], v[36:39], v[112:115]
    v_mfma_f32_16x16x32_bf16 v[64:67], v[140:143], v[160:163], v[64:67]
    s_waitcnt vmcnt(9)
    buffer_load_dwordx4 v[212:215], v18, s[32:35], s64 offen offset:0 sc1
    v_mfma_f32_16x16x32_bf16 v[68:71], v[136:139], v[160:163], v[68:71]
    s_waitcnt vmcnt(9)
    buffer_load_dwordx4 v[144:147], v18, s[32:35], s65 offen offset:0 sc1
    v_mfma_f32_16x16x32_bf16 v[72:75], v[132:135], v[160:163], v[72:75]
    s_waitcnt vmcnt(9)
    buffer_load_dwordx4 v[44:47], v18, s[32:35], s66 offen offset:0 sc1
    v_mfma_f32_16x16x32_bf16 v[76:79], v[252:255], v[160:163], v[76:79]
    v_mfma_f32_16x16x32_bf16 v[92:95], v[252:255], v[32:35], v[92:95]
    s_waitcnt vmcnt(9)
    buffer_load_dwordx4 v[40:43], v18, s[32:35], s64 offen offset:1024 sc1
    v_mfma_f32_16x16x32_bf16 v[88:91], v[132:135], v[32:35], v[88:91]
    ds_read_b64_tr_b16 v[232:233], v22 offset:36864
    v_mfma_f32_16x16x32_bf16 v[84:87], v[136:139], v[32:35], v[84:87]
    ds_read_b64_tr_b16 v[234:235], v22 offset:38912
    v_mfma_f32_16x16x32_bf16 v[80:83], v[140:143], v[32:35], v[80:83]
    v_mfma_f32_16x16x32_bf16 v[96:99], v[140:143], v[208:211], v[96:99]
    ds_read_b64_tr_b16 v[52:53], v23 offset:36864
    v_mfma_f32_16x16x32_bf16 v[100:103], v[136:139], v[208:211], v[100:103]
    ds_read_b64_tr_b16 v[54:55], v23 offset:38912
    v_mfma_f32_16x16x32_bf16 v[104:107], v[132:135], v[208:211], v[104:107]
    ds_read_b64_tr_b16 v[56:57], v24 offset:36864
    v_mfma_f32_16x16x32_bf16 v[108:111], v[252:255], v[208:211], v[108:111]
    v_mfma_f32_16x16x32_bf16 v[124:127], v[252:255], v[216:219], v[124:127]
    ds_read_b64_tr_b16 v[58:59], v24 offset:38912
    v_mfma_f32_16x16x32_bf16 v[120:123], v[132:135], v[216:219], v[120:123]
    ds_read_b64_tr_b16 v[36:37], v25 offset:36864
L_stub6:
    s_cbranch_execz L_warmed
    v_mfma_f32_16x16x32_bf16 v[116:119], v[136:139], v[216:219], v[116:119]
    ds_read_b64_tr_b16 v[38:39], v25 offset:38912
    v_mfma_f32_16x16x32_bf16 v[112:115], v[140:143], v[216:219], v[112:115]
    v_mfma_f32_16x16x32_bf16 v[64:67], v[128:131], v[180:183], v[64:67]
    s_waitcnt vmcnt(9)
    buffer_load_dwordx4 v[60:63], v18, s[32:35], s65 offen offset:1024 sc1
    v_mfma_f32_16x16x32_bf16 v[68:71], v[8:11], v[180:183], v[68:71]
    v_mfma_f32_16x16x32_bf16 v[72:75], v[176:179], v[180:183], v[72:75]
    v_mfma_f32_16x16x32_bf16 v[76:79], v[184:187], v[180:183], v[76:79]
    v_mfma_f32_16x16x32_bf16 v[92:95], v[184:187], v[48:51], v[92:95]
    s_waitcnt vmcnt(9)
    buffer_load_dwordx4 v[160:163], v18, s[32:35], s66 offen offset:1024 sc1
    v_mfma_f32_16x16x32_bf16 v[88:91], v[176:179], v[48:51], v[88:91]
    v_mfma_f32_16x16x32_bf16 v[84:87], v[8:11], v[48:51], v[84:87]
    v_mfma_f32_16x16x32_bf16 v[80:83], v[128:131], v[48:51], v[80:83]
    v_mfma_f32_16x16x32_bf16 v[96:99], v[128:131], v[240:243], v[96:99]
    s_waitcnt vmcnt(9)
    buffer_load_dwordx4 v[32:35], v18, s[32:35], s64 offen offset:2048 sc1
    v_mfma_f32_16x16x32_bf16 v[100:103], v[8:11], v[240:243], v[100:103]
    v_mfma_f32_16x16x32_bf16 v[104:107], v[176:179], v[240:243], v[104:107]
    v_mfma_f32_16x16x32_bf16 v[108:111], v[184:187], v[240:243], v[108:111]
    v_mfma_f32_16x16x32_bf16 v[124:127], v[184:187], v[244:247], v[124:127]
    s_waitcnt vmcnt(9)
    buffer_load_dwordx4 v[208:211], v18, s[32:35], s65 offen offset:2048 sc1
    v_mfma_f32_16x16x32_bf16 v[120:123], v[176:179], v[244:247], v[120:123]
    v_mfma_f32_16x16x32_bf16 v[116:119], v[8:11], v[244:247], v[116:119]
    v_mfma_f32_16x16x32_bf16 v[112:115], v[128:131], v[244:247], v[112:115]
    s_waitcnt lgkmcnt(15)
    v_mfma_f32_16x16x32_bf16 v[64:67], v[156:159], v[236:239], v[64:67]
    s_waitcnt vmcnt(9)
    buffer_load_dwordx4 v[252:255], v18, s[32:35], s66 offen offset:2048 sc1
    v_mfma_f32_16x16x32_bf16 v[68:71], v[152:155], v[236:239], v[68:71]
    v_mfma_f32_16x16x32_bf16 v[72:75], v[148:151], v[236:239], v[72:75]
    v_mfma_f32_16x16x32_bf16 v[76:79], v[192:195], v[236:239], v[76:79]
    v_mfma_f32_16x16x32_bf16 v[92:95], v[192:195], v[228:231], v[92:95]
    s_waitcnt vmcnt(9)
    buffer_load_dwordx4 v[132:135], v18, s[32:35], s64 offen offset:3072 sc1
    v_mfma_f32_16x16x32_bf16 v[88:91], v[148:151], v[228:231], v[88:91]
    v_mfma_f32_16x16x32_bf16 v[84:87], v[152:155], v[228:231], v[84:87]
    v_mfma_f32_16x16x32_bf16 v[80:83], v[156:159], v[228:231], v[80:83]
    v_mfma_f32_16x16x32_bf16 v[96:99], v[156:159], v[220:223], v[96:99]
    s_waitcnt vmcnt(9)
    buffer_load_dwordx4 v[136:139], v18, s[32:35], s65 offen offset:3072 sc1
    v_mfma_f32_16x16x32_bf16 v[100:103], v[152:155], v[220:223], v[100:103]
    v_mfma_f32_16x16x32_bf16 v[104:107], v[148:151], v[220:223], v[104:107]
    v_mfma_f32_16x16x32_bf16 v[108:111], v[192:195], v[220:223], v[108:111]
    v_mfma_f32_16x16x32_bf16 v[124:127], v[192:195], v[248:251], v[124:127]
    s_waitcnt vmcnt(9)
    buffer_load_dwordx4 v[216:219], v18, s[32:35], s66 offen offset:3072 sc1
    v_mfma_f32_16x16x32_bf16 v[120:123], v[148:151], v[248:251], v[120:123]
    v_mfma_f32_16x16x32_bf16 v[116:119], v[152:155], v[248:251], v[116:119]
    v_mfma_f32_16x16x32_bf16 v[112:115], v[156:159], v[248:251], v[112:115]
    v_mfma_f32_16x16x32_bf16 v[64:67], v[172:175], v[212:215], v[64:67]
    v_mfma_f32_16x16x32_bf16 v[68:71], v[168:171], v[212:215], v[68:71]
    v_mfma_f32_16x16x32_bf16 v[72:75], v[164:167], v[212:215], v[72:75]
    v_mfma_f32_16x16x32_bf16 v[76:79], v[200:203], v[212:215], v[76:79]
    s_waitcnt lgkmcnt(14)
    v_mfma_f32_16x16x32_bf16 v[64:67], v[204:207], v[144:147], v[64:67]
    s_waitcnt lgkmcnt(12)
    v_mfma_f32_16x16x32_bf16 v[68:71], v[196:199], v[144:147], v[68:71]
    s_waitcnt lgkmcnt(10)
    v_mfma_f32_16x16x32_bf16 v[72:75], v[188:191], v[144:147], v[72:75]
    s_waitcnt lgkmcnt(8)
    v_mfma_f32_16x16x32_bf16 v[76:79], v[224:227], v[144:147], v[76:79]
    s_waitcnt vmcnt(9)
    s_waitcnt lgkmcnt(6)
    v_mfma_f32_16x16x32_bf16 v[64:67], v[232:235], v[44:47], v[64:67]
    s_waitcnt lgkmcnt(4)
    v_mfma_f32_16x16x32_bf16 v[68:71], v[52:55], v[44:47], v[68:71]
    s_waitcnt lgkmcnt(2)
    v_mfma_f32_16x16x32_bf16 v[72:75], v[56:59], v[44:47], v[72:75]
    s_waitcnt lgkmcnt(0)
    v_mfma_f32_16x16x32_bf16 v[76:79], v[36:39], v[44:47], v[76:79]
    s_waitcnt vmcnt(8)
    v_mfma_f32_16x16x32_bf16 v[80:83], v[172:175], v[40:43], v[80:83]
    v_mfma_f32_16x16x32_bf16 v[84:87], v[168:171], v[40:43], v[84:87]
    v_mfma_f32_16x16x32_bf16 v[88:91], v[164:167], v[40:43], v[88:91]
    v_mfma_f32_16x16x32_bf16 v[92:95], v[200:203], v[40:43], v[92:95]
    s_waitcnt vmcnt(7)
    v_mfma_f32_16x16x32_bf16 v[80:83], v[204:207], v[60:63], v[80:83]
    ds_write_b128 v6, v[64:67] offset:0
    v_mfma_f32_16x16x32_bf16 v[84:87], v[196:199], v[60:63], v[84:87]
    v_mfma_f32_16x16x32_bf16 v[88:91], v[188:191], v[60:63], v[88:91]
    ds_write_b128 v7, v[68:71] offset:0
    v_mfma_f32_16x16x32_bf16 v[92:95], v[224:227], v[60:63], v[92:95]
    s_waitcnt vmcnt(6)
    v_mfma_f32_16x16x32_bf16 v[80:83], v[232:235], v[160:163], v[80:83]
    ds_write_b128 v6, v[72:75] offset:128
    v_mfma_f32_16x16x32_bf16 v[84:87], v[52:55], v[160:163], v[84:87]
    v_mfma_f32_16x16x32_bf16 v[88:91], v[56:59], v[160:163], v[88:91]
    ds_write_b128 v7, v[76:79] offset:128
    v_mfma_f32_16x16x32_bf16 v[92:95], v[36:39], v[160:163], v[92:95]
    s_waitcnt vmcnt(5)
    v_mfma_f32_16x16x32_bf16 v[96:99], v[172:175], v[32:35], v[96:99]
    v_mfma_f32_16x16x32_bf16 v[100:103], v[168:171], v[32:35], v[100:103]
    v_mfma_f32_16x16x32_bf16 v[104:107], v[164:167], v[32:35], v[104:107]
    v_mfma_f32_16x16x32_bf16 v[108:111], v[200:203], v[32:35], v[108:111]
    s_waitcnt vmcnt(4)
    v_mfma_f32_16x16x32_bf16 v[96:99], v[204:207], v[208:211], v[96:99]
    ds_write_b128 v6, v[80:83] offset:4096
    v_mfma_f32_16x16x32_bf16 v[100:103], v[196:199], v[208:211], v[100:103]
    v_mfma_f32_16x16x32_bf16 v[104:107], v[188:191], v[208:211], v[104:107]
    ds_write_b128 v7, v[84:87] offset:4096
    v_mfma_f32_16x16x32_bf16 v[108:111], v[224:227], v[208:211], v[108:111]
    s_waitcnt vmcnt(3)
    v_mfma_f32_16x16x32_bf16 v[96:99], v[232:235], v[252:255], v[96:99]
    ds_write_b128 v6, v[88:91] offset:4224
    v_mfma_f32_16x16x32_bf16 v[100:103], v[52:55], v[252:255], v[100:103]
    v_mfma_f32_16x16x32_bf16 v[104:107], v[56:59], v[252:255], v[104:107]
    ds_write_b128 v7, v[92:95] offset:4224
    v_mfma_f32_16x16x32_bf16 v[108:111], v[36:39], v[252:255], v[108:111]
    s_waitcnt vmcnt(2)
    v_mfma_f32_16x16x32_bf16 v[112:115], v[172:175], v[132:135], v[112:115]
    v_mfma_f32_16x16x32_bf16 v[116:119], v[168:171], v[132:135], v[116:119]
    v_mfma_f32_16x16x32_bf16 v[120:123], v[164:167], v[132:135], v[120:123]
    v_mfma_f32_16x16x32_bf16 v[124:127], v[200:203], v[132:135], v[124:127]
    s_waitcnt vmcnt(1)
    v_mfma_f32_16x16x32_bf16 v[112:115], v[204:207], v[136:139], v[112:115]
    ds_write_b128 v6, v[96:99] offset:32768
    v_mfma_f32_16x16x32_bf16 v[116:119], v[196:199], v[136:139], v[116:119]
    v_mfma_f32_16x16x32_bf16 v[120:123], v[188:191], v[136:139], v[120:123]
    ds_write_b128 v7, v[100:103] offset:32768
    v_mfma_f32_16x16x32_bf16 v[124:127], v[224:227], v[136:139], v[124:127]
    s_waitcnt vmcnt(0)
    v_mfma_f32_16x16x32_bf16 v[112:115], v[232:235], v[216:219], v[112:115]
    ds_write_b128 v6, v[104:107] offset:32896
    v_mfma_f32_16x16x32_bf16 v[116:119], v[52:55], v[216:219], v[116:119]
    v_mfma_f32_16x16x32_bf16 v[120:123], v[56:59], v[216:219], v[120:123]
    ds_write_b128 v7, v[108:111] offset:32896
    v_mfma_f32_16x16x32_bf16 v[124:127], v[36:39], v[216:219], v[124:127]
    s_nop 4
    ds_write_b128 v6, v[112:115] offset:36864
    ds_write_b128 v7, v[116:119] offset:36864
    ds_write_b128 v6, v[120:123] offset:36992
    ds_write_b128 v7, v[124:127] offset:36992
    s_branch L_final
.p2align 12
L_C:

    s_cmp_ge_u32 s42, 28
    s_cbranch_scc1 L_C_free
    s_setprio 2
    v_and_b32 v16, 15, v2
    s_lshl_b32 s44, s36, 12
    v_lshl_add_u32 v17, v16, 7, s44
    v_lshrrev_b32 v18, 1, v16
    v_xor_b32 v18, v18, v5
    v_lshl_add_u32 v8, v18, 4, v17
    v_add_u32 v8, 65536, v8
    v_xor_b32 v9, 64, v8
    v_and_b32 v16, 1, v5
    v_bfe_u32 v17, v2, 2, 2
    v_lshl_add_u32 v18, v16, 3, v17
    v_lshlrev_b32 v18, 7, v18
    v_lshrrev_b32 v19, 5, v2
    v_lshl_add_u32 v18, v19, 12, v18
    v_and_b32 v20, 3, v2
    v_lshl_add_u32 v18, v20, 3, v18
    v_and_b32 v17, 3, v3
    v_lshl_add_u32 v12, v17, 5, v18
    v_add_u32 v12, 65536, v12
    v_xor_b32 v13, 32, v12
    v_xor_b32 v14, 64, v12
    v_xor_b32 v15, 96, v12
    s_lshr_b32 s44, s37, 2
    s_mul_i32 s44, s44, 1835008
    s_and_b32 s45, s37, 3
    s_lshl_b32 s45, s45, 2
    s_add_u32 s45, s45, s36
    s_lshl_b32 s45, s45, 11
    s_add_u32 s44, s44, s45
    s_lshl_b32 s45, s38, 17
    s_add_u32 s44, s44, s45
    v_lshl_add_u32 v6, v2, 4, s44
    s_mul_i32 s57, s37, 14
    s_add_u32 s57, s57, s38
    s_lshl_b32 s57, s57, 7
    s_lshl_b32 s45, s36, 2
    s_add_u32 s57, s57, s45
    s_add_u32 s57, s57, 8388608
    s_mov_b32 s60, 0x8000
    s_mov_b32 s61, 0x10000
    s_mov_b32 s62, 0x18000
    s_mov_b64 exec, 0
    s_cmp_eq_u32 s36, 0
    s_cbranch_scc1 L_stub0
    s_cmp_eq_u32 s36, 1
    s_cbranch_scc1 L_stub1
    s_cmp_eq_u32 s36, 2
    s_cbranch_scc1 L_stub2
    s_branch L_stub3
L_warmed:
    s_mov_b64 exec, -1
    s_waitcnt lgkmcnt(0)

    s_barrier
    ds_read_b128 v[128:131], v8 offset:0
    ds_read_b128 v[132:135], v8 offset:2048
    ds_read_b128 v[136:139], v9 offset:0
    ds_read_b128 v[140:143], v9 offset:2048
    ds_read_b64_tr_b16 v[32:33], v12 offset:16384
    ds_read_b64_tr_b16 v[34:35], v12 offset:16896
    ds_read_b64_tr_b16 v[36:37], v12 offset:24576
    ds_read_b64_tr_b16 v[38:39], v12 offset:25088
    ds_read_b64_tr_b16 v[40:41], v12 offset:18432
    ds_read_b64_tr_b16 v[42:43], v12 offset:18944
    ds_read_b64_tr_b16 v[44:45], v12 offset:26624
    ds_read_b64_tr_b16 v[46:47], v12 offset:27136
    ds_read_b64_tr_b16 v[48:49], v13 offset:16384
    ds_read_b64_tr_b16 v[50:51], v13 offset:16896
    ds_read_b64_tr_b16 v[52:53], v13 offset:24576
    ds_read_b64_tr_b16 v[54:55], v13 offset:25088
    s_waitcnt lgkmcnt(8)
    v_mfma_f32_16x16x32_bf16 v[64:67], v[32:35], v[128:131], 0
    ds_read_b64_tr_b16 v[56:57], v13 offset:18432
    ds_read_b64_tr_b16 v[58:59], v13 offset:18944
    v_mfma_f32_16x16x32_bf16 v[64:67], v[36:39], v[136:139], v[64:67]
    v_xor_b32 v12, 65536, v12
    v_xor_b32 v8, 65536, v8
    v_mfma_f32_16x16x32_bf16 v[68:71], v[36:39], v[140:143], 0
    ds_read_b64_tr_b16 v[60:61], v13 offset:26624
    ds_read_b64_tr_b16 v[62:63], v13 offset:27136
    v_mfma_f32_16x16x32_bf16 v[68:71], v[32:35], v[132:135], v[68:71]
    v_xor_b32 v13, 65536, v13
    s_waitcnt lgkmcnt(8)
    v_mfma_f32_16x16x32_bf16 v[76:79], v[40:43], v[132:135], 0
    ds_read_b64_tr_b16 v[32:33], v14 offset:16384
    ds_read_b64_tr_b16 v[34:35], v14 offset:16896
    v_mfma_f32_16x16x32_bf16 v[76:79], v[44:47], v[140:143], v[76:79]
    v_xor_b32 v9, 65536, v9
    v_mfma_f32_16x16x32_bf16 v[72:75], v[44:47], v[136:139], 0
    ds_read_b64_tr_b16 v[36:37], v14 offset:24576
    ds_read_b64_tr_b16 v[38:39], v14 offset:25088
    v_mfma_f32_16x16x32_bf16 v[72:75], v[40:43], v[128:131], v[72:75]
    s_waitcnt lgkmcnt(8)
    v_mfma_f32_16x16x32_bf16 v[80:83], v[48:51], v[128:131], 0
    ds_read_b64_tr_b16 v[40:41], v14 offset:18432
    ds_read_b64_tr_b16 v[42:43], v14 offset:18944
    v_mfma_f32_16x16x32_bf16 v[80:83], v[52:55], v[136:139], v[80:83]
    v_mfma_f32_16x16x32_bf16 v[84:87], v[52:55], v[140:143], 0
    ds_read_b64_tr_b16 v[44:45], v14 offset:26624
    ds_read_b64_tr_b16 v[46:47], v14 offset:27136
    v_mfma_f32_16x16x32_bf16 v[84:87], v[48:51], v[132:135], v[84:87]
    v_xor_b32 v14, 65536, v14
    s_waitcnt lgkmcnt(8)
    v_mfma_f32_16x16x32_bf16 v[92:95], v[56:59], v[132:135], 0
    ds_read_b64_tr_b16 v[48:49], v15 offset:16384
    ds_read_b64_tr_b16 v[50:51], v15 offset:16896
    v_mfma_f32_16x16x32_bf16 v[92:95], v[60:63], v[140:143], v[92:95]
    v_mfma_f32_16x16x32_bf16 v[88:91], v[60:63], v[136:139], 0
    ds_read_b64_tr_b16 v[52:53], v15 offset:24576
    ds_read_b64_tr_b16 v[54:55], v15 offset:25088
    v_mfma_f32_16x16x32_bf16 v[88:91], v[56:59], v[128:131], v[88:91]
    s_waitcnt lgkmcnt(8)
    v_mfma_f32_16x16x32_bf16 v[96:99], v[32:35], v[128:131], 0
    ds_read_b64_tr_b16 v[56:57], v15 offset:18432
    ds_read_b64_tr_b16 v[58:59], v15 offset:18944
    v_mfma_f32_16x16x32_bf16 v[96:99], v[36:39], v[136:139], v[96:99]
    v_mfma_f32_16x16x32_bf16 v[100:103], v[36:39], v[140:143], 0
    ds_read_b64_tr_b16 v[60:61], v15 offset:26624
    ds_read_b64_tr_b16 v[62:63], v15 offset:27136
    v_mfma_f32_16x16x32_bf16 v[100:103], v[32:35], v[132:135], v[100:103]
    s_barrier
    s_waitcnt lgkmcnt(8)
    v_mfma_f32_16x16x32_bf16 v[108:111], v[40:43], v[132:135], 0
    ds_read_b64_tr_b16 v[32:33], v12 offset:16384
    ds_read_b64_tr_b16 v[34:35], v12 offset:16896
    v_mfma_f32_16x16x32_bf16 v[108:111], v[44:47], v[140:143], v[108:111]
    ds_read_b128 v[144:147], v8 offset:0
    ds_read_b128 v[152:155], v9 offset:0
    v_mfma_f32_16x16x32_bf16 v[104:107], v[44:47], v[136:139], 0
    ds_read_b64_tr_b16 v[36:37], v12 offset:24576
    ds_read_b64_tr_b16 v[38:39], v12 offset:25088
    v_mfma_f32_16x16x32_bf16 v[104:107], v[40:43], v[128:131], v[104:107]
    ds_read_b128 v[148:151], v8 offset:2048
    s_waitcnt lgkmcnt(11)
    v_mfma_f32_16x16x32_bf16 v[112:115], v[48:51], v[128:131], 0
    ds_read_b64_tr_b16 v[40:41], v12 offset:18432
    ds_read_b64_tr_b16 v[42:43], v12 offset:18944
    v_mfma_f32_16x16x32_bf16 v[112:115], v[52:55], v[136:139], v[112:115]
    ds_read_b128 v[156:159], v9 offset:2048
    v_xor_b32 v15, 65536, v15
    v_mfma_f32_16x16x32_bf16 v[116:119], v[52:55], v[140:143], 0
    ds_read_b64_tr_b16 v[44:45], v12 offset:26624
    ds_read_b64_tr_b16 v[46:47], v12 offset:27136
    v_mfma_f32_16x16x32_bf16 v[116:119], v[48:51], v[132:135], v[116:119]
    s_waitcnt lgkmcnt(12)
    v_mfma_f32_16x16x32_bf16 v[124:127], v[56:59], v[132:135], 0
    ds_read_b64_tr_b16 v[48:49], v13 offset:16384
    ds_read_b64_tr_b16 v[50:51], v13 offset:16896
    v_mfma_f32_16x16x32_bf16 v[124:127], v[60:63], v[140:143], v[124:127]
    v_mfma_f32_16x16x32_bf16 v[120:123], v[60:63], v[136:139], 0
    ds_read_b64_tr_b16 v[52:53], v13 offset:24576
    ds_read_b64_tr_b16 v[54:55], v13 offset:25088
    v_mfma_f32_16x16x32_bf16 v[120:123], v[56:59], v[128:131], v[120:123]
    s_waitcnt lgkmcnt(6)
    v_mfma_f32_16x16x32_bf16 v[64:67], v[32:35], v[144:147], v[64:67]
    ds_read_b64_tr_b16 v[56:57], v13 offset:18432
    ds_read_b64_tr_b16 v[58:59], v13 offset:18944
    v_mfma_f32_16x16x32_bf16 v[64:67], v[36:39], v[152:155], v[64:67]
    v_mfma_f32_16x16x32_bf16 v[68:71], v[36:39], v[156:159], v[68:71]
    ds_read_b64_tr_b16 v[60:61], v13 offset:26624
    ds_read_b64_tr_b16 v[62:63], v13 offset:27136
    v_mfma_f32_16x16x32_bf16 v[68:71], v[32:35], v[148:151], v[68:71]
    s_waitcnt lgkmcnt(8)
    v_mfma_f32_16x16x32_bf16 v[76:79], v[40:43], v[148:151], v[76:79]
    ds_read_b64_tr_b16 v[32:33], v14 offset:16384
    ds_read_b64_tr_b16 v[34:35], v14 offset:16896
    v_mfma_f32_16x16x32_bf16 v[76:79], v[44:47], v[156:159], v[76:79]
    v_mfma_f32_16x16x32_bf16 v[72:75], v[44:47], v[152:155], v[72:75]
    ds_read_b64_tr_b16 v[36:37], v14 offset:24576
    ds_read_b64_tr_b16 v[38:39], v14 offset:25088
    v_mfma_f32_16x16x32_bf16 v[72:75], v[40:43], v[144:147], v[72:75]
    s_waitcnt lgkmcnt(8)
    v_mfma_f32_16x16x32_bf16 v[80:83], v[48:51], v[144:147], v[80:83]
    ds_read_b64_tr_b16 v[40:41], v14 offset:18432
    ds_read_b64_tr_b16 v[42:43], v14 offset:18944
    v_mfma_f32_16x16x32_bf16 v[80:83], v[52:55], v[152:155], v[80:83]
    v_mfma_f32_16x16x32_bf16 v[84:87], v[52:55], v[156:159], v[84:87]
    ds_read_b64_tr_b16 v[44:45], v14 offset:26624
    ds_read_b64_tr_b16 v[46:47], v14 offset:27136
    v_mfma_f32_16x16x32_bf16 v[84:87], v[48:51], v[148:151], v[84:87]
    s_waitcnt lgkmcnt(8)
    v_mfma_f32_16x16x32_bf16 v[92:95], v[56:59], v[148:151], v[92:95]
    ds_read_b64_tr_b16 v[48:49], v15 offset:16384
    ds_read_b64_tr_b16 v[50:51], v15 offset:16896
    v_mfma_f32_16x16x32_bf16 v[92:95], v[60:63], v[156:159], v[92:95]
    v_mfma_f32_16x16x32_bf16 v[88:91], v[60:63], v[152:155], v[88:91]
    ds_read_b64_tr_b16 v[52:53], v15 offset:24576
    ds_read_b64_tr_b16 v[54:55], v15 offset:25088
    v_mfma_f32_16x16x32_bf16 v[88:91], v[56:59], v[144:147], v[88:91]
    s_waitcnt lgkmcnt(8)
    v_mfma_f32_16x16x32_bf16 v[96:99], v[32:35], v[144:147], v[96:99]
    ds_read_b64_tr_b16 v[56:57], v15 offset:18432
    ds_read_b64_tr_b16 v[58:59], v15 offset:18944
    v_mfma_f32_16x16x32_bf16 v[96:99], v[36:39], v[152:155], v[96:99]
    v_mfma_f32_16x16x32_bf16 v[100:103], v[36:39], v[156:159], v[100:103]
    ds_read_b64_tr_b16 v[60:61], v15 offset:26624
    ds_read_b64_tr_b16 v[62:63], v15 offset:27136
    v_mfma_f32_16x16x32_bf16 v[100:103], v[32:35], v[148:151], v[100:103]
    s_barrier
    s_waitcnt lgkmcnt(8)
    v_mfma_f32_16x16x32_bf16 v[108:111], v[40:43], v[148:151], v[108:111]
    ds_read_b64_tr_b16 v[32:33], v12 offset:49152
    ds_read_b64_tr_b16 v[34:35], v12 offset:49664
    v_mfma_f32_16x16x32_bf16 v[108:111], v[44:47], v[156:159], v[108:111]
    ds_read_b128 v[160:163], v8 offset:32768
    ds_read_b128 v[168:171], v9 offset:32768
    v_mfma_f32_16x16x32_bf16 v[104:107], v[44:47], v[152:155], v[104:107]
    ds_read_b64_tr_b16 v[36:37], v12 offset:57344
    ds_read_b64_tr_b16 v[38:39], v12 offset:57856
    v_mfma_f32_16x16x32_bf16 v[104:107], v[40:43], v[144:147], v[104:107]
    ds_read_b128 v[164:167], v8 offset:34816
    s_waitcnt lgkmcnt(11)
    v_mfma_f32_16x16x32_bf16 v[112:115], v[48:51], v[144:147], v[112:115]
    ds_read_b64_tr_b16 v[40:41], v12 offset:51200
    ds_read_b64_tr_b16 v[42:43], v12 offset:51712
    v_mfma_f32_16x16x32_bf16 v[112:115], v[52:55], v[152:155], v[112:115]
    ds_read_b128 v[172:175], v9 offset:34816
    v_xor_b32 v8, 65536, v8
    v_mfma_f32_16x16x32_bf16 v[116:119], v[52:55], v[156:159], v[116:119]
    ds_read_b64_tr_b16 v[44:45], v12 offset:59392
    ds_read_b64_tr_b16 v[46:47], v12 offset:59904
    v_mfma_f32_16x16x32_bf16 v[116:119], v[48:51], v[148:151], v[116:119]
    v_xor_b32 v12, 65536, v12
    s_waitcnt lgkmcnt(12)
    v_mfma_f32_16x16x32_bf16 v[124:127], v[56:59], v[148:151], v[124:127]
    ds_read_b64_tr_b16 v[48:49], v13 offset:49152
    ds_read_b64_tr_b16 v[50:51], v13 offset:49664
    v_mfma_f32_16x16x32_bf16 v[124:127], v[60:63], v[156:159], v[124:127]
    v_xor_b32 v9, 65536, v9
    v_mfma_f32_16x16x32_bf16 v[120:123], v[60:63], v[152:155], v[120:123]
    ds_read_b64_tr_b16 v[52:53], v13 offset:57344
    ds_read_b64_tr_b16 v[54:55], v13 offset:57856
    v_mfma_f32_16x16x32_bf16 v[120:123], v[56:59], v[144:147], v[120:123]
    s_waitcnt lgkmcnt(6)
    v_mfma_f32_16x16x32_bf16 v[64:67], v[32:35], v[160:163], v[64:67]
    ds_read_b64_tr_b16 v[56:57], v13 offset:51200
    ds_read_b64_tr_b16 v[58:59], v13 offset:51712
    v_mfma_f32_16x16x32_bf16 v[64:67], v[36:39], v[168:171], v[64:67]
    v_mfma_f32_16x16x32_bf16 v[68:71], v[36:39], v[172:175], v[68:71]
    ds_read_b64_tr_b16 v[60:61], v13 offset:59392
    ds_read_b64_tr_b16 v[62:63], v13 offset:59904
    v_mfma_f32_16x16x32_bf16 v[68:71], v[32:35], v[164:167], v[68:71]
    s_barrier
    s_waitcnt lgkmcnt(8)
    v_mfma_f32_16x16x32_bf16 v[76:79], v[40:43], v[164:167], v[76:79]
    ds_read_b64_tr_b16 v[32:33], v14 offset:49152
    ds_read_b64_tr_b16 v[34:35], v14 offset:49664
    v_mfma_f32_16x16x32_bf16 v[76:79], v[44:47], v[172:175], v[76:79]
    ds_read_b128 v[176:179], v8 offset:32768
    ds_read_b128 v[184:187], v9 offset:32768
    v_mfma_f32_16x16x32_bf16 v[72:75], v[44:47], v[168:171], v[72:75]
    ds_read_b64_tr_b16 v[36:37], v14 offset:57344
    ds_read_b64_tr_b16 v[38:39], v14 offset:57856
    v_mfma_f32_16x16x32_bf16 v[72:75], v[40:43], v[160:163], v[72:75]
    ds_read_b128 v[180:183], v8 offset:34816
    s_waitcnt lgkmcnt(11)
    v_mfma_f32_16x16x32_bf16 v[80:83], v[48:51], v[160:163], v[80:83]
    ds_read_b64_tr_b16 v[40:41], v14 offset:51200
    ds_read_b64_tr_b16 v[42:43], v14 offset:51712
    v_mfma_f32_16x16x32_bf16 v[80:83], v[52:55], v[168:171], v[80:83]
    ds_read_b128 v[188:191], v9 offset:34816
    v_xor_b32 v13, 65536, v13
    v_mfma_f32_16x16x32_bf16 v[84:87], v[52:55], v[172:175], v[84:87]
    ds_read_b64_tr_b16 v[44:45], v14 offset:59392
    ds_read_b64_tr_b16 v[46:47], v14 offset:59904
    v_mfma_f32_16x16x32_bf16 v[84:87], v[48:51], v[164:167], v[84:87]
    s_barrier
    s_waitcnt lgkmcnt(12)
    v_mfma_f32_16x16x32_bf16 v[92:95], v[56:59], v[164:167], v[92:95]
    ds_read_b64_tr_b16 v[48:49], v15 offset:49152
    ds_read_b64_tr_b16 v[50:51], v15 offset:49664
    v_mfma_f32_16x16x32_bf16 v[92:95], v[60:63], v[172:175], v[92:95]
    ds_read_b128 v[192:195], v8 offset:49152
    ds_read_b128 v[200:203], v9 offset:49152
    v_mfma_f32_16x16x32_bf16 v[88:91], v[60:63], v[168:171], v[88:91]
    ds_read_b64_tr_b16 v[52:53], v15 offset:57344
    ds_read_b64_tr_b16 v[54:55], v15 offset:57856
    v_mfma_f32_16x16x32_bf16 v[88:91], v[56:59], v[160:163], v[88:91]
    ds_read_b128 v[196:199], v8 offset:51200
    s_waitcnt lgkmcnt(13)
    v_mfma_f32_16x16x32_bf16 v[96:99], v[32:35], v[160:163], v[96:99]
    ds_read_b64_tr_b16 v[56:57], v15 offset:51200
    ds_read_b64_tr_b16 v[58:59], v15 offset:51712
    v_mfma_f32_16x16x32_bf16 v[96:99], v[36:39], v[168:171], v[96:99]
    ds_read_b128 v[204:207], v9 offset:51200
    v_xor_b32 v14, 65536, v14
    v_xor_b32 v8, 196608, v8
L_stub0:
    s_cbranch_execz L_stub4
    v_mfma_f32_16x16x32_bf16 v[100:103], v[36:39], v[172:175], v[100:103]
    ds_read_b64_tr_b16 v[60:61], v15 offset:59392
    ds_read_b64_tr_b16 v[62:63], v15 offset:59904
    v_mfma_f32_16x16x32_bf16 v[100:103], v[32:35], v[164:167], v[100:103]
    s_waitcnt lgkmcnt(0)
    s_barrier
    v_xor_b32 v9, 196608, v9
    v_mfma_f32_16x16x32_bf16 v[108:111], v[40:43], v[164:167], v[108:111]
    ds_read_b64_tr_b16 v[32:33], v12 offset:0
    ds_read_b64_tr_b16 v[34:35], v12 offset:512
    v_mfma_f32_16x16x32_bf16 v[108:111], v[44:47], v[172:175], v[108:111]
    ds_read_b128 v[208:211], v8 offset:0
    ds_read_b128 v[216:219], v9 offset:0
    v_mfma_f32_16x16x32_bf16 v[104:107], v[44:47], v[168:171], v[104:107]
    ds_read_b64_tr_b16 v[36:37], v12 offset:8192
    ds_read_b64_tr_b16 v[38:39], v12 offset:8704
    v_mfma_f32_16x16x32_bf16 v[104:107], v[40:43], v[160:163], v[104:107]
    ds_read_b128 v[212:215], v8 offset:2048
    v_mfma_f32_16x16x32_bf16 v[112:115], v[48:51], v[160:163], v[112:115]
    ds_read_b64_tr_b16 v[40:41], v12 offset:2048
    ds_read_b64_tr_b16 v[42:43], v12 offset:2560
    v_mfma_f32_16x16x32_bf16 v[112:115], v[52:55], v[168:171], v[112:115]
    ds_read_b128 v[220:223], v9 offset:2048
    v_xor_b32 v15, 65536, v15
    v_mfma_f32_16x16x32_bf16 v[116:119], v[52:55], v[172:175], v[116:119]
    ds_read_b64_tr_b16 v[44:45], v12 offset:10240
    ds_read_b64_tr_b16 v[46:47], v12 offset:10752
    v_mfma_f32_16x16x32_bf16 v[116:119], v[48:51], v[164:167], v[116:119]
    ds_read_b128 v[224:227], v8 offset:16384
    v_mfma_f32_16x16x32_bf16 v[124:127], v[56:59], v[164:167], v[124:127]
    ds_read_b64_tr_b16 v[48:49], v13 offset:0
    ds_read_b64_tr_b16 v[50:51], v13 offset:512
    v_mfma_f32_16x16x32_bf16 v[124:127], v[60:63], v[172:175], v[124:127]
    ds_read_b128 v[228:231], v8 offset:18432
    ds_read_b128 v[232:235], v9 offset:16384
    v_mfma_f32_16x16x32_bf16 v[120:123], v[60:63], v[168:171], v[120:123]
    ds_read_b64_tr_b16 v[52:53], v13 offset:8192
    ds_read_b64_tr_b16 v[54:55], v13 offset:8704
    v_mfma_f32_16x16x32_bf16 v[120:123], v[56:59], v[160:163], v[120:123]
    ds_read_b128 v[236:239], v9 offset:18432
    v_xor_b32 v8, 196608, v8
    s_waitcnt lgkmcnt(14)
    v_mfma_f32_16x16x32_bf16 v[64:67], v[32:35], v[176:179], v[64:67]
    ds_read_b64_tr_b16 v[56:57], v13 offset:2048
    ds_read_b64_tr_b16 v[58:59], v13 offset:2560
    v_mfma_f32_16x16x32_bf16 v[64:67], v[36:39], v[184:187], v[64:67]
    ds_read_b128 v[240:243], v8 offset:16384
    v_xor_b32 v12, 65536, v12
    v_xor_b32 v9, 196608, v9
    v_mfma_f32_16x16x32_bf16 v[68:71], v[36:39], v[188:191], v[68:71]
    ds_read_b64_tr_b16 v[60:61], v13 offset:10240
    ds_read_b64_tr_b16 v[62:63], v13 offset:10752
    v_mfma_f32_16x16x32_bf16 v[68:71], v[32:35], v[180:183], v[68:71]
    ds_read_b128 v[244:247], v8 offset:18432
    s_waitcnt lgkmcnt(14)
    v_mfma_f32_16x16x32_bf16 v[76:79], v[40:43], v[180:183], v[76:79]
    ds_read_b64_tr_b16 v[32:33], v14 offset:0
    ds_read_b64_tr_b16 v[34:35], v14 offset:512
    v_mfma_f32_16x16x32_bf16 v[76:79], v[44:47], v[188:191], v[76:79]
    ds_read_b128 v[248:251], v9 offset:16384
    v_xor_b32 v13, 65536, v13
    v_mfma_f32_16x16x32_bf16 v[72:75], v[44:47], v[184:187], v[72:75]
    ds_read_b64_tr_b16 v[36:37], v14 offset:8192
    ds_read_b64_tr_b16 v[38:39], v14 offset:8704
    v_mfma_f32_16x16x32_bf16 v[72:75], v[40:43], v[176:179], v[72:75]
    ds_read_b128 v[252:255], v9 offset:18432
    s_waitcnt lgkmcnt(13)
    v_mfma_f32_16x16x32_bf16 v[80:83], v[48:51], v[176:179], v[80:83]
    ds_read_b64_tr_b16 v[40:41], v14 offset:2048
    ds_read_b64_tr_b16 v[42:43], v14 offset:2560
    v_mfma_f32_16x16x32_bf16 v[80:83], v[52:55], v[184:187], v[80:83]
    v_mfma_f32_16x16x32_bf16 v[84:87], v[52:55], v[188:191], v[84:87]
    ds_read_b64_tr_b16 v[44:45], v14 offset:10240
    ds_read_b64_tr_b16 v[46:47], v14 offset:10752
    v_mfma_f32_16x16x32_bf16 v[84:87], v[48:51], v[180:183], v[84:87]
    v_xor_b32 v14, 65536, v14
    s_waitcnt lgkmcnt(11)
    v_mfma_f32_16x16x32_bf16 v[92:95], v[56:59], v[180:183], v[92:95]
    ds_read_b64_tr_b16 v[48:49], v15 offset:0
    ds_read_b64_tr_b16 v[50:51], v15 offset:512
    v_mfma_f32_16x16x32_bf16 v[92:95], v[60:63], v[188:191], v[92:95]
    v_mfma_f32_16x16x32_bf16 v[88:91], v[60:63], v[184:187], v[88:91]
    ds_read_b64_tr_b16 v[52:53], v15 offset:8192
    ds_read_b64_tr_b16 v[54:55], v15 offset:8704
    v_mfma_f32_16x16x32_bf16 v[88:91], v[56:59], v[176:179], v[88:91]
    s_waitcnt lgkmcnt(9)
    v_mfma_f32_16x16x32_bf16 v[96:99], v[32:35], v[176:179], v[96:99]
    ds_read_b64_tr_b16 v[56:57], v15 offset:2048
    ds_read_b64_tr_b16 v[58:59], v15 offset:2560
    v_mfma_f32_16x16x32_bf16 v[96:99], v[36:39], v[184:187], v[96:99]
    v_mfma_f32_16x16x32_bf16 v[100:103], v[36:39], v[188:191], v[100:103]
    ds_read_b64_tr_b16 v[60:61], v15 offset:10240
    ds_read_b64_tr_b16 v[62:63], v15 offset:10752
    v_mfma_f32_16x16x32_bf16 v[100:103], v[32:35], v[180:183], v[100:103]
    s_barrier
    s_waitcnt lgkmcnt(8)
    v_mfma_f32_16x16x32_bf16 v[108:111], v[40:43], v[180:183], v[108:111]
    ds_read_b64_tr_b16 v[32:33], v12 offset:0
    ds_read_b64_tr_b16 v[34:35], v12 offset:512
    v_mfma_f32_16x16x32_bf16 v[108:111], v[44:47], v[188:191], v[108:111]
    v_xor_b32 v15, 65536, v15
    v_mfma_f32_16x16x32_bf16 v[104:107], v[44:47], v[184:187], v[104:107]
    ds_read_b64_tr_b16 v[36:37], v12 offset:8192
    ds_read_b64_tr_b16 v[38:39], v12 offset:8704
    v_mfma_f32_16x16x32_bf16 v[104:107], v[40:43], v[176:179], v[104:107]
    s_waitcnt lgkmcnt(8)
    v_mfma_f32_16x16x32_bf16 v[112:115], v[48:51], v[176:179], v[112:115]
    ds_read_b64_tr_b16 v[40:41], v12 offset:2048
    ds_read_b64_tr_b16 v[42:43], v12 offset:2560
    v_mfma_f32_16x16x32_bf16 v[112:115], v[52:55], v[184:187], v[112:115]
    v_mfma_f32_16x16x32_bf16 v[116:119], v[52:55], v[188:191], v[116:119]
    ds_read_b64_tr_b16 v[44:45], v12 offset:10240
    ds_read_b64_tr_b16 v[46:47], v12 offset:10752
    v_mfma_f32_16x16x32_bf16 v[116:119], v[48:51], v[180:183], v[116:119]
    s_waitcnt lgkmcnt(8)
    v_mfma_f32_16x16x32_bf16 v[124:127], v[56:59], v[180:183], v[124:127]
    ds_read_b64_tr_b16 v[48:49], v13 offset:0
    ds_read_b64_tr_b16 v[50:51], v13 offset:512
    v_mfma_f32_16x16x32_bf16 v[124:127], v[60:63], v[188:191], v[124:127]
    v_mfma_f32_16x16x32_bf16 v[120:123], v[60:63], v[184:187], v[120:123]
    ds_read_b64_tr_b16 v[52:53], v13 offset:8192
    ds_read_b64_tr_b16 v[54:55], v13 offset:8704
    v_mfma_f32_16x16x32_bf16 v[120:123], v[56:59], v[176:179], v[120:123]
    s_waitcnt lgkmcnt(8)
    v_mfma_f32_16x16x32_bf16 v[64:67], v[32:35], v[192:195], v[64:67]
    ds_read_b64_tr_b16 v[56:57], v13 offset:2048
    ds_read_b64_tr_b16 v[58:59], v13 offset:2560
    v_mfma_f32_16x16x32_bf16 v[64:67], v[36:39], v[200:203], v[64:67]
    v_mfma_f32_16x16x32_bf16 v[68:71], v[36:39], v[204:207], v[68:71]
    ds_read_b64_tr_b16 v[60:61], v13 offset:10240
    ds_read_b64_tr_b16 v[62:63], v13 offset:10752
    v_mfma_f32_16x16x32_bf16 v[68:71], v[32:35], v[196:199], v[68:71]
    s_waitcnt lgkmcnt(8)
    v_mfma_f32_16x16x32_bf16 v[76:79], v[40:43], v[196:199], v[76:79]
    ds_read_b64_tr_b16 v[32:33], v14 offset:0
    ds_read_b64_tr_b16 v[34:35], v14 offset:512
    v_mfma_f32_16x16x32_bf16 v[76:79], v[44:47], v[204:207], v[76:79]
    v_mfma_f32_16x16x32_bf16 v[72:75], v[44:47], v[200:203], v[72:75]
    ds_read_b64_tr_b16 v[36:37], v14 offset:8192
    ds_read_b64_tr_b16 v[38:39], v14 offset:8704
    v_mfma_f32_16x16x32_bf16 v[72:75], v[40:43], v[192:195], v[72:75]
    s_waitcnt lgkmcnt(8)
    v_mfma_f32_16x16x32_bf16 v[80:83], v[48:51], v[192:195], v[80:83]
    ds_read_b64_tr_b16 v[40:41], v14 offset:2048
    ds_read_b64_tr_b16 v[42:43], v14 offset:2560
    v_mfma_f32_16x16x32_bf16 v[80:83], v[52:55], v[200:203], v[80:83]
    v_mfma_f32_16x16x32_bf16 v[84:87], v[52:55], v[204:207], v[84:87]
    ds_read_b64_tr_b16 v[44:45], v14 offset:10240
    ds_read_b64_tr_b16 v[46:47], v14 offset:10752
    v_mfma_f32_16x16x32_bf16 v[84:87], v[48:51], v[196:199], v[84:87]
    s_waitcnt lgkmcnt(8)
    v_mfma_f32_16x16x32_bf16 v[92:95], v[56:59], v[196:199], v[92:95]
    ds_read_b64_tr_b16 v[48:49], v15 offset:0
    ds_read_b64_tr_b16 v[50:51], v15 offset:512
    v_mfma_f32_16x16x32_bf16 v[92:95], v[60:63], v[204:207], v[92:95]
    v_mfma_f32_16x16x32_bf16 v[88:91], v[60:63], v[200:203], v[88:91]
    ds_read_b64_tr_b16 v[52:53], v15 offset:8192
    ds_read_b64_tr_b16 v[54:55], v15 offset:8704
    v_mfma_f32_16x16x32_bf16 v[88:91], v[56:59], v[192:195], v[88:91]
    s_waitcnt lgkmcnt(8)
    v_mfma_f32_16x16x32_bf16 v[96:99], v[32:35], v[192:195], v[96:99]
    ds_read_b64_tr_b16 v[56:57], v15 offset:2048
    ds_read_b64_tr_b16 v[58:59], v15 offset:2560
    v_mfma_f32_16x16x32_bf16 v[96:99], v[36:39], v[200:203], v[96:99]
    v_mfma_f32_16x16x32_bf16 v[100:103], v[36:39], v[204:207], v[100:103]
    ds_read_b64_tr_b16 v[60:61], v15 offset:10240
    ds_read_b64_tr_b16 v[62:63], v15 offset:10752
    v_mfma_f32_16x16x32_bf16 v[100:103], v[32:35], v[196:199], v[100:103]
    s_waitcnt lgkmcnt(8)
    v_mfma_f32_16x16x32_bf16 v[108:111], v[40:43], v[196:199], v[108:111]
    ds_read_b64_tr_b16 v[32:33], v12 offset:16384
    ds_read_b64_tr_b16 v[34:35], v12 offset:16896
    v_mfma_f32_16x16x32_bf16 v[108:111], v[44:47], v[204:207], v[108:111]
    v_mfma_f32_16x16x32_bf16 v[104:107], v[44:47], v[200:203], v[104:107]
    ds_read_b64_tr_b16 v[36:37], v12 offset:24576
    ds_read_b64_tr_b16 v[38:39], v12 offset:25088
    v_mfma_f32_16x16x32_bf16 v[104:107], v[40:43], v[192:195], v[104:107]
    s_waitcnt lgkmcnt(8)
    v_mfma_f32_16x16x32_bf16 v[112:115], v[48:51], v[192:195], v[112:115]
    ds_read_b64_tr_b16 v[40:41], v12 offset:18432
    ds_read_b64_tr_b16 v[42:43], v12 offset:18944
    v_mfma_f32_16x16x32_bf16 v[112:115], v[52:55], v[200:203], v[112:115]
    v_mfma_f32_16x16x32_bf16 v[116:119], v[52:55], v[204:207], v[116:119]
    ds_read_b64_tr_b16 v[44:45], v12 offset:26624
    ds_read_b64_tr_b16 v[46:47], v12 offset:27136
    v_mfma_f32_16x16x32_bf16 v[116:119], v[48:51], v[196:199], v[116:119]
    s_waitcnt lgkmcnt(8)
    v_mfma_f32_16x16x32_bf16 v[124:127], v[56:59], v[196:199], v[124:127]
    ds_read_b64_tr_b16 v[48:49], v13 offset:16384
    ds_read_b64_tr_b16 v[50:51], v13 offset:16896
    v_mfma_f32_16x16x32_bf16 v[124:127], v[60:63], v[204:207], v[124:127]
    s_barrier
    v_mfma_f32_16x16x32_bf16 v[120:123], v[60:63], v[200:203], v[120:123]
    ds_read_b64_tr_b16 v[52:53], v13 offset:24576
    ds_read_b64_tr_b16 v[54:55], v13 offset:25088
    v_mfma_f32_16x16x32_bf16 v[120:123], v[56:59], v[192:195], v[120:123]
    s_waitcnt lgkmcnt(8)
    v_mfma_f32_16x16x32_bf16 v[64:67], v[32:35], v[208:211], v[64:67]
    ds_read_b64_tr_b16 v[56:57], v13 offset:18432
    ds_read_b64_tr_b16 v[58:59], v13 offset:18944
    v_mfma_f32_16x16x32_bf16 v[64:67], v[36:39], v[216:219], v[64:67]
    v_mfma_f32_16x16x32_bf16 v[68:71], v[36:39], v[220:223], v[68:71]
    ds_read_b64_tr_b16 v[60:61], v13 offset:26624
    ds_read_b64_tr_b16 v[62:63], v13 offset:27136
    v_mfma_f32_16x16x32_bf16 v[68:71], v[32:35], v[212:215], v[68:71]
    s_waitcnt lgkmcnt(8)
    v_mfma_f32_16x16x32_bf16 v[76:79], v[40:43], v[212:215], v[76:79]
    ds_read_b64_tr_b16 v[32:33], v14 offset:16384
    ds_read_b64_tr_b16 v[34:35], v14 offset:16896
    v_mfma_f32_16x16x32_bf16 v[76:79], v[44:47], v[220:223], v[76:79]
    v_mfma_f32_16x16x32_bf16 v[72:75], v[44:47], v[216:219], v[72:75]
    ds_read_b64_tr_b16 v[36:37], v14 offset:24576
    ds_read_b64_tr_b16 v[38:39], v14 offset:25088
    v_mfma_f32_16x16x32_bf16 v[72:75], v[40:43], v[208:211], v[72:75]
    s_waitcnt lgkmcnt(8)
    v_mfma_f32_16x16x32_bf16 v[80:83], v[48:51], v[208:211], v[80:83]
    ds_read_b64_tr_b16 v[40:41], v14 offset:18432
    ds_read_b64_tr_b16 v[42:43], v14 offset:18944
    v_mfma_f32_16x16x32_bf16 v[80:83], v[52:55], v[216:219], v[80:83]
    v_mfma_f32_16x16x32_bf16 v[84:87], v[52:55], v[220:223], v[84:87]
    ds_read_b64_tr_b16 v[44:45], v14 offset:26624
    ds_read_b64_tr_b16 v[46:47], v14 offset:27136
    v_mfma_f32_16x16x32_bf16 v[84:87], v[48:51], v[212:215], v[84:87]
    s_waitcnt lgkmcnt(8)
    v_mfma_f32_16x16x32_bf16 v[92:95], v[56:59], v[212:215], v[92:95]
    ds_read_b64_tr_b16 v[48:49], v15 offset:16384
    ds_read_b64_tr_b16 v[50:51], v15 offset:16896
    v_mfma_f32_16x16x32_bf16 v[92:95], v[60:63], v[220:223], v[92:95]
    v_mfma_f32_16x16x32_bf16 v[88:91], v[60:63], v[216:219], v[88:91]
    ds_read_b64_tr_b16 v[52:53], v15 offset:24576
    ds_read_b64_tr_b16 v[54:55], v15 offset:25088
    v_mfma_f32_16x16x32_bf16 v[88:91], v[56:59], v[208:211], v[88:91]
    s_waitcnt lgkmcnt(8)
    v_mfma_f32_16x16x32_bf16 v[96:99], v[32:35], v[208:211], v[96:99]
    ds_read_b64_tr_b16 v[56:57], v15 offset:18432
    ds_read_b64_tr_b16 v[58:59], v15 offset:18944
    v_mfma_f32_16x16x32_bf16 v[96:99], v[36:39], v[216:219], v[96:99]
    v_mfma_f32_16x16x32_bf16 v[100:103], v[36:39], v[220:223], v[100:103]
    ds_read_b64_tr_b16 v[60:61], v15 offset:26624
    ds_read_b64_tr_b16 v[62:63], v15 offset:27136
    v_mfma_f32_16x16x32_bf16 v[100:103], v[32:35], v[212:215], v[100:103]
    s_waitcnt lgkmcnt(8)
    v_mfma_f32_16x16x32_bf16 v[108:111], v[40:43], v[212:215], v[108:111]
    ds_read_b64_tr_b16 v[32:33], v12 offset:32768
    ds_read_b64_tr_b16 v[34:35], v12 offset:33280
    v_mfma_f32_16x16x32_bf16 v[108:111], v[44:47], v[220:223], v[108:111]
    v_mfma_f32_16x16x32_bf16 v[104:107], v[44:47], v[216:219], v[104:107]
    ds_read_b64_tr_b16 v[36:37], v12 offset:40960
    ds_read_b64_tr_b16 v[38:39], v12 offset:41472
    v_mfma_f32_16x16x32_bf16 v[104:107], v[40:43], v[208:211], v[104:107]
    s_waitcnt lgkmcnt(8)
    v_mfma_f32_16x16x32_bf16 v[112:115], v[48:51], v[208:211], v[112:115]
    ds_read_b64_tr_b16 v[40:41], v12 offset:34816
    ds_read_b64_tr_b16 v[42:43], v12 offset:35328
    v_mfma_f32_16x16x32_bf16 v[112:115], v[52:55], v[216:219], v[112:115]
    v_mfma_f32_16x16x32_bf16 v[116:119], v[52:55], v[220:223], v[116:119]
    ds_read_b64_tr_b16 v[44:45], v12 offset:43008
    ds_read_b64_tr_b16 v[46:47], v12 offset:43520
    v_mfma_f32_16x16x32_bf16 v[116:119], v[48:51], v[212:215], v[116:119]
    s_waitcnt lgkmcnt(8)
    v_mfma_f32_16x16x32_bf16 v[124:127], v[56:59], v[212:215], v[124:127]
    ds_read_b64_tr_b16 v[48:49], v13 offset:32768
    ds_read_b64_tr_b16 v[50:51], v13 offset:33280
    v_mfma_f32_16x16x32_bf16 v[124:127], v[60:63], v[220:223], v[124:127]
    v_mfma_f32_16x16x32_bf16 v[120:123], v[60:63], v[216:219], v[120:123]
    ds_read_b64_tr_b16 v[52:53], v13 offset:40960
    ds_read_b64_tr_b16 v[54:55], v13 offset:41472
    v_mfma_f32_16x16x32_bf16 v[120:123], v[56:59], v[208:211], v[120:123]
    s_waitcnt lgkmcnt(8)
    v_mfma_f32_16x16x32_bf16 v[64:67], v[32:35], v[224:227], v[64:67]
L_stub1:
    s_cbranch_execz L_stub5
    ds_read_b64_tr_b16 v[56:57], v13 offset:34816
    ds_read_b64_tr_b16 v[58:59], v13 offset:35328
    v_mfma_f32_16x16x32_bf16 v[64:67], v[36:39], v[232:235], v[64:67]
    v_mfma_f32_16x16x32_bf16 v[68:71], v[36:39], v[236:239], v[68:71]
    ds_read_b64_tr_b16 v[60:61], v13 offset:43008
    ds_read_b64_tr_b16 v[62:63], v13 offset:43520
    v_mfma_f32_16x16x32_bf16 v[68:71], v[32:35], v[228:231], v[68:71]
    s_waitcnt lgkmcnt(8)
    v_mfma_f32_16x16x32_bf16 v[76:79], v[40:43], v[228:231], v[76:79]
    ds_read_b64_tr_b16 v[32:33], v14 offset:32768
    ds_read_b64_tr_b16 v[34:35], v14 offset:33280
    v_mfma_f32_16x16x32_bf16 v[76:79], v[44:47], v[236:239], v[76:79]
    v_mfma_f32_16x16x32_bf16 v[72:75], v[44:47], v[232:235], v[72:75]
    ds_read_b64_tr_b16 v[36:37], v14 offset:40960
    ds_read_b64_tr_b16 v[38:39], v14 offset:41472
    v_mfma_f32_16x16x32_bf16 v[72:75], v[40:43], v[224:227], v[72:75]
    s_waitcnt lgkmcnt(8)
    v_mfma_f32_16x16x32_bf16 v[80:83], v[48:51], v[224:227], v[80:83]
    ds_read_b64_tr_b16 v[40:41], v14 offset:34816
    ds_read_b64_tr_b16 v[42:43], v14 offset:35328
    v_mfma_f32_16x16x32_bf16 v[80:83], v[52:55], v[232:235], v[80:83]
    s_barrier
    v_mfma_f32_16x16x32_bf16 v[84:87], v[52:55], v[236:239], v[84:87]
    ds_read_b64_tr_b16 v[44:45], v14 offset:43008
    ds_read_b64_tr_b16 v[46:47], v14 offset:43520
    v_mfma_f32_16x16x32_bf16 v[84:87], v[48:51], v[228:231], v[84:87]
    s_waitcnt lgkmcnt(8)
    v_mfma_f32_16x16x32_bf16 v[92:95], v[56:59], v[228:231], v[92:95]
    ds_read_b64_tr_b16 v[48:49], v15 offset:32768
    ds_read_b64_tr_b16 v[50:51], v15 offset:33280
    v_mfma_f32_16x16x32_bf16 v[92:95], v[60:63], v[236:239], v[92:95]
    v_mfma_f32_16x16x32_bf16 v[88:91], v[60:63], v[232:235], v[88:91]
    ds_read_b64_tr_b16 v[52:53], v15 offset:40960
    ds_read_b64_tr_b16 v[54:55], v15 offset:41472
    v_mfma_f32_16x16x32_bf16 v[88:91], v[56:59], v[224:227], v[88:91]
    s_waitcnt lgkmcnt(8)
    v_mfma_f32_16x16x32_bf16 v[96:99], v[32:35], v[224:227], v[96:99]
    ds_read_b64_tr_b16 v[56:57], v15 offset:34816
    ds_read_b64_tr_b16 v[58:59], v15 offset:35328
    v_mfma_f32_16x16x32_bf16 v[96:99], v[36:39], v[232:235], v[96:99]
    v_mfma_f32_16x16x32_bf16 v[100:103], v[36:39], v[236:239], v[100:103]
    ds_read_b64_tr_b16 v[60:61], v15 offset:43008
    ds_read_b64_tr_b16 v[62:63], v15 offset:43520
    v_mfma_f32_16x16x32_bf16 v[100:103], v[32:35], v[228:231], v[100:103]
    s_waitcnt lgkmcnt(8)
    v_mfma_f32_16x16x32_bf16 v[108:111], v[40:43], v[228:231], v[108:111]
    ds_read_b64_tr_b16 v[32:33], v12 offset:49152
    ds_read_b64_tr_b16 v[34:35], v12 offset:49664
    v_mfma_f32_16x16x32_bf16 v[108:111], v[44:47], v[236:239], v[108:111]
    v_mfma_f32_16x16x32_bf16 v[104:107], v[44:47], v[232:235], v[104:107]
    ds_read_b64_tr_b16 v[36:37], v12 offset:57344
    ds_read_b64_tr_b16 v[38:39], v12 offset:57856
    v_mfma_f32_16x16x32_bf16 v[104:107], v[40:43], v[224:227], v[104:107]
    s_waitcnt lgkmcnt(8)
    v_mfma_f32_16x16x32_bf16 v[112:115], v[48:51], v[224:227], v[112:115]
    ds_read_b64_tr_b16 v[40:41], v12 offset:51200
    ds_read_b64_tr_b16 v[42:43], v12 offset:51712
    v_mfma_f32_16x16x32_bf16 v[112:115], v[52:55], v[232:235], v[112:115]
    v_mfma_f32_16x16x32_bf16 v[116:119], v[52:55], v[236:239], v[116:119]
    ds_read_b64_tr_b16 v[44:45], v12 offset:59392
    ds_read_b64_tr_b16 v[46:47], v12 offset:59904
    v_mfma_f32_16x16x32_bf16 v[116:119], v[48:51], v[228:231], v[116:119]
    v_xor_b32 v12, 65536, v12
    s_waitcnt lgkmcnt(8)
    v_mfma_f32_16x16x32_bf16 v[124:127], v[56:59], v[228:231], v[124:127]
    ds_read_b64_tr_b16 v[48:49], v13 offset:49152
    ds_read_b64_tr_b16 v[50:51], v13 offset:49664
    v_mfma_f32_16x16x32_bf16 v[124:127], v[60:63], v[236:239], v[124:127]
    v_mfma_f32_16x16x32_bf16 v[120:123], v[60:63], v[232:235], v[120:123]
    ds_read_b64_tr_b16 v[52:53], v13 offset:57344
    ds_read_b64_tr_b16 v[54:55], v13 offset:57856
    v_mfma_f32_16x16x32_bf16 v[120:123], v[56:59], v[224:227], v[120:123]
    s_waitcnt lgkmcnt(8)
    v_mfma_f32_16x16x32_bf16 v[64:67], v[32:35], v[240:243], v[64:67]
    ds_read_b64_tr_b16 v[56:57], v13 offset:51200
    v_mfma_f32_16x16x32_bf16 v[64:67], v[36:39], v[248:251], v[64:67]
    ds_read_b64_tr_b16 v[58:59], v13 offset:51712
    v_mfma_f32_16x16x32_bf16 v[68:71], v[36:39], v[252:255], v[68:71]
    ds_read_b64_tr_b16 v[60:61], v13 offset:59392
    v_mfma_f32_16x16x32_bf16 v[68:71], v[32:35], v[244:247], v[68:71]
    ds_read_b64_tr_b16 v[62:63], v13 offset:59904
    s_waitcnt lgkmcnt(8)
    v_mfma_f32_16x16x32_bf16 v[76:79], v[40:43], v[244:247], v[76:79]
    ds_read_b64_tr_b16 v[32:33], v14 offset:49152
    v_xor_b32 v13, 65536, v13
    v_mfma_f32_16x16x32_bf16 v[76:79], v[44:47], v[252:255], v[76:79]
    ds_read_b64_tr_b16 v[34:35], v14 offset:49664
    v_mfma_f32_16x16x32_bf16 v[72:75], v[44:47], v[248:251], v[72:75]
    ds_read_b64_tr_b16 v[36:37], v14 offset:57344
    v_mfma_f32_16x16x32_bf16 v[72:75], v[40:43], v[240:243], v[72:75]
    ds_read_b64_tr_b16 v[38:39], v14 offset:57856
    s_waitcnt lgkmcnt(8)
    v_mfma_f32_16x16x32_bf16 v[80:83], v[48:51], v[240:243], v[80:83]
    ds_read_b64_tr_b16 v[40:41], v14 offset:51200
    v_mfma_f32_16x16x32_bf16 v[80:83], v[52:55], v[248:251], v[80:83]
    ds_read_b64_tr_b16 v[42:43], v14 offset:51712
    v_mfma_f32_16x16x32_bf16 v[84:87], v[52:55], v[252:255], v[84:87]
    ds_read_b64_tr_b16 v[44:45], v14 offset:59392
    v_mfma_f32_16x16x32_bf16 v[84:87], v[48:51], v[244:247], v[84:87]
    ds_read_b64_tr_b16 v[46:47], v14 offset:59904
    s_waitcnt lgkmcnt(8)
    v_mfma_f32_16x16x32_bf16 v[92:95], v[56:59], v[244:247], v[92:95]
    ds_read_b64_tr_b16 v[48:49], v15 offset:49152
    v_xor_b32 v14, 65536, v14
    v_mfma_f32_16x16x32_bf16 v[92:95], v[60:63], v[252:255], v[92:95]
    ds_read_b64_tr_b16 v[50:51], v15 offset:49664
    v_mul_f32 v64, v64, v72
    v_mfma_f32_16x16x32_bf16 v[88:91], v[60:63], v[248:251], v[88:91]
    ds_read_b64_tr_b16 v[52:53], v15 offset:57344
    v_mul_f32 v65, v65, v73
    v_mfma_f32_16x16x32_bf16 v[88:91], v[56:59], v[240:243], v[88:91]
    ds_read_b64_tr_b16 v[54:55], v15 offset:57856
    v_cvt_pk_bf16_f32 v16, v64, v65
    s_waitcnt lgkmcnt(8)
    v_mfma_f32_16x16x32_bf16 v[96:99], v[32:35], v[240:243], v[96:99]
    ds_read_b64_tr_b16 v[56:57], v15 offset:51200
    v_mul_f32 v66, v66, v74
    v_mfma_f32_16x16x32_bf16 v[96:99], v[36:39], v[248:251], v[96:99]
    ds_read_b64_tr_b16 v[58:59], v15 offset:51712
    v_mul_f32 v67, v67, v75
    v_mfma_f32_16x16x32_bf16 v[100:103], v[36:39], v[252:255], v[100:103]
    ds_read_b64_tr_b16 v[60:61], v15 offset:59392
    v_cvt_pk_bf16_f32 v17, v66, v67
    v_mfma_f32_16x16x32_bf16 v[100:103], v[32:35], v[244:247], v[100:103]
    ds_read_b64_tr_b16 v[62:63], v15 offset:59904
    v_xor_b32 v15, 65536, v15
    v_mul_f32 v68, v68, v76
    s_waitcnt lgkmcnt(8)
    v_mfma_f32_16x16x32_bf16 v[108:111], v[40:43], v[244:247], v[108:111]
    ds_read_b64_tr_b16 v[32:33], v12 offset:32768
    v_mul_f32 v69, v69, v77
    v_mfma_f32_16x16x32_bf16 v[108:111], v[44:47], v[252:255], v[108:111]
    ds_read_b64_tr_b16 v[34:35], v12 offset:33280
    v_cvt_pk_bf16_f32 v20, v68, v69
    v_mfma_f32_16x16x32_bf16 v[104:107], v[44:47], v[248:251], v[104:107]
    ds_read_b64_tr_b16 v[36:37], v12 offset:40960
    v_mul_f32 v70, v70, v78
    v_mfma_f32_16x16x32_bf16 v[104:107], v[40:43], v[240:243], v[104:107]
    ds_read_b64_tr_b16 v[38:39], v12 offset:41472
    v_mul_f32 v71, v71, v79
    s_waitcnt lgkmcnt(8)
    v_mfma_f32_16x16x32_bf16 v[112:115], v[48:51], v[240:243], v[112:115]
    ds_read_b64_tr_b16 v[40:41], v12 offset:34816
    v_cvt_pk_bf16_f32 v21, v70, v71
    v_mfma_f32_16x16x32_bf16 v[112:115], v[52:55], v[248:251], v[112:115]
    ds_read_b64_tr_b16 v[42:43], v12 offset:35328
    v_mul_f32 v80, v80, v88
    v_mfma_f32_16x16x32_bf16 v[116:119], v[52:55], v[252:255], v[116:119]
    ds_read_b64_tr_b16 v[44:45], v12 offset:43008
    v_mul_f32 v81, v81, v89
    v_mfma_f32_16x16x32_bf16 v[116:119], v[48:51], v[244:247], v[116:119]
    ds_read_b64_tr_b16 v[46:47], v12 offset:43520
    v_cvt_pk_bf16_f32 v18, v80, v81
    s_waitcnt lgkmcnt(8)
    v_mfma_f32_16x16x32_bf16 v[124:127], v[56:59], v[244:247], v[124:127]
    ds_read_b64_tr_b16 v[48:49], v12 offset:49152
    v_mul_f32 v82, v82, v90
    v_mfma_f32_16x16x32_bf16 v[124:127], v[60:63], v[252:255], v[124:127]
    ds_read_b64_tr_b16 v[50:51], v12 offset:49664
    v_mul_f32 v83, v83, v91
    v_mfma_f32_16x16x32_bf16 v[120:123], v[60:63], v[248:251], v[120:123]
    ds_read_b64_tr_b16 v[52:53], v12 offset:57344
    v_cvt_pk_bf16_f32 v19, v82, v83
    v_mfma_f32_16x16x32_bf16 v[120:123], v[56:59], v[240:243], v[120:123]
    ds_read_b64_tr_b16 v[54:55], v12 offset:57856
    v_mul_f32 v84, v84, v92
    v_mul_f32 v85, v85, v93
    s_waitcnt lgkmcnt(8)
    v_mfma_f32_16x16x32_bf16 v[64:67], v[32:35], v[128:131], 0
    ds_read_b64_tr_b16 v[56:57], v12 offset:51200
    buffer_store_dwordx4 v[16:19], v6, s[32:35], 0 offen offset:0 sc1
    v_mfma_f32_16x16x32_bf16 v[64:67], v[36:39], v[136:139], v[64:67]
    ds_read_b64_tr_b16 v[58:59], v12 offset:51712
    v_cvt_pk_bf16_f32 v22, v84, v85
    v_mfma_f32_16x16x32_bf16 v[68:71], v[36:39], v[140:143], 0
    ds_read_b64_tr_b16 v[60:61], v12 offset:59392
    v_mul_f32 v86, v86, v94
    v_mfma_f32_16x16x32_bf16 v[68:71], v[32:35], v[132:135], v[68:71]
    ds_read_b64_tr_b16 v[62:63], v12 offset:59904
    v_xor_b32 v12, 196608, v12
    v_mul_f32 v87, v87, v95
    s_waitcnt lgkmcnt(8)
    v_mfma_f32_16x16x32_bf16 v[76:79], v[40:43], v[132:135], 0
    ds_read_b64_tr_b16 v[32:33], v13 offset:32768
    v_cvt_pk_bf16_f32 v23, v86, v87
    v_mfma_f32_16x16x32_bf16 v[76:79], v[44:47], v[140:143], v[76:79]
    ds_read_b64_tr_b16 v[34:35], v13 offset:33280
    buffer_store_dwordx4 v[20:23], v6, s[32:35], 0 offen offset:1024 sc1
    v_mul_f32 v96, v96, v104
    v_mfma_f32_16x16x32_bf16 v[72:75], v[44:47], v[136:139], 0
    ds_read_b64_tr_b16 v[36:37], v13 offset:40960
    v_mul_f32 v97, v97, v105
    v_mfma_f32_16x16x32_bf16 v[72:75], v[40:43], v[128:131], v[72:75]
    ds_read_b64_tr_b16 v[38:39], v13 offset:41472
    v_cvt_pk_bf16_f32 v24, v96, v97
    s_waitcnt lgkmcnt(8)
    v_mfma_f32_16x16x32_bf16 v[64:67], v[48:51], v[144:147], v[64:67]
    ds_read_b64_tr_b16 v[40:41], v13 offset:34816
    v_mul_f32 v98, v98, v106
    v_mfma_f32_16x16x32_bf16 v[64:67], v[52:55], v[152:155], v[64:67]
    ds_read_b64_tr_b16 v[42:43], v13 offset:35328
    v_mul_f32 v99, v99, v107
    v_mfma_f32_16x16x32_bf16 v[68:71], v[52:55], v[156:159], v[68:71]
    ds_read_b64_tr_b16 v[44:45], v13 offset:43008
    v_cvt_pk_bf16_f32 v25, v98, v99
    v_mfma_f32_16x16x32_bf16 v[68:71], v[48:51], v[148:151], v[68:71]
    ds_read_b64_tr_b16 v[46:47], v13 offset:43520
    v_mul_f32 v100, v100, v108
    s_waitcnt lgkmcnt(8)
    v_mfma_f32_16x16x32_bf16 v[76:79], v[56:59], v[148:151], v[76:79]
    ds_read_b64_tr_b16 v[48:49], v13 offset:49152
    v_mul_f32 v101, v101, v109
    v_mfma_f32_16x16x32_bf16 v[76:79], v[60:63], v[156:159], v[76:79]
    ds_read_b64_tr_b16 v[50:51], v13 offset:49664
    v_cvt_pk_bf16_f32 v28, v100, v101
    v_mfma_f32_16x16x32_bf16 v[72:75], v[60:63], v[152:155], v[72:75]
    ds_read_b64_tr_b16 v[52:53], v13 offset:57344
    v_mul_f32 v102, v102, v110
    v_mfma_f32_16x16x32_bf16 v[72:75], v[56:59], v[144:147], v[72:75]
    ds_read_b64_tr_b16 v[54:55], v13 offset:57856
    v_mul_f32 v103, v103, v111
    s_waitcnt lgkmcnt(8)
    v_mfma_f32_16x16x32_bf16 v[80:83], v[32:35], v[128:131], 0
    ds_read_b64_tr_b16 v[56:57], v13 offset:51200
    v_cvt_pk_bf16_f32 v29, v102, v103
    v_mfma_f32_16x16x32_bf16 v[80:83], v[36:39], v[136:139], v[80:83]
    ds_read_b64_tr_b16 v[58:59], v13 offset:51712
    v_mul_f32 v112, v112, v120
    v_mfma_f32_16x16x32_bf16 v[84:87], v[36:39], v[140:143], 0
    ds_read_b64_tr_b16 v[60:61], v13 offset:59392
    v_mul_f32 v113, v113, v121
    v_mfma_f32_16x16x32_bf16 v[84:87], v[32:35], v[132:135], v[84:87]
    ds_read_b64_tr_b16 v[62:63], v13 offset:59904
    v_xor_b32 v13, 196608, v13
    v_cvt_pk_bf16_f32 v26, v112, v113
    s_waitcnt lgkmcnt(8)
    v_mfma_f32_16x16x32_bf16 v[92:95], v[40:43], v[132:135], 0
    ds_read_b64_tr_b16 v[32:33], v14 offset:32768
    v_mul_f32 v114, v114, v122
    v_mfma_f32_16x16x32_bf16 v[92:95], v[44:47], v[140:143], v[92:95]
    ds_read_b64_tr_b16 v[34:35], v14 offset:33280
    s_barrier
    v_mul_f32 v115, v115, v123
    v_mfma_f32_16x16x32_bf16 v[88:91], v[44:47], v[136:139], 0
    ds_read_b64_tr_b16 v[36:37], v14 offset:40960
    v_cvt_pk_bf16_f32 v27, v114, v115
    v_mfma_f32_16x16x32_bf16 v[88:91], v[40:43], v[128:131], v[88:91]
    ds_read_b64_tr_b16 v[38:39], v14 offset:41472
    v_mul_f32 v116, v116, v124
    v_mul_f32 v117, v117, v125
    s_waitcnt lgkmcnt(8)
    v_mfma_f32_16x16x32_bf16 v[80:83], v[48:51], v[144:147], v[80:83]
    ds_read_b64_tr_b16 v[40:41], v14 offset:34816
    buffer_store_dwordx4 v[24:27], v6, s[32:35], s60 offen offset:0 sc1
    v_mfma_f32_16x16x32_bf16 v[80:83], v[52:55], v[152:155], v[80:83]
    ds_read_b64_tr_b16 v[42:43], v14 offset:35328
    v_cvt_pk_bf16_f32 v30, v116, v117
    v_mfma_f32_16x16x32_bf16 v[84:87], v[52:55], v[156:159], v[84:87]
    ds_read_b64_tr_b16 v[44:45], v14 offset:43008
    v_mul_f32 v118, v118, v126
    v_mfma_f32_16x16x32_bf16 v[84:87], v[48:51], v[148:151], v[84:87]
    ds_read_b64_tr_b16 v[46:47], v14 offset:43520
    v_mul_f32 v119, v119, v127
    s_waitcnt lgkmcnt(8)
    v_mfma_f32_16x16x32_bf16 v[92:95], v[56:59], v[148:151], v[92:95]
    ds_read_b64_tr_b16 v[48:49], v14 offset:49152
    v_cvt_pk_bf16_f32 v31, v118, v119
    v_mfma_f32_16x16x32_bf16 v[92:95], v[60:63], v[156:159], v[92:95]
    ds_read_b64_tr_b16 v[50:51], v14 offset:49664
    buffer_store_dwordx4 v[28:31], v6, s[32:35], s60 offen offset:1024 sc1
    v_mfma_f32_16x16x32_bf16 v[88:91], v[60:63], v[152:155], v[88:91]
    ds_read_b64_tr_b16 v[52:53], v14 offset:57344
    v_mfma_f32_16x16x32_bf16 v[88:91], v[56:59], v[144:147], v[88:91]
    ds_read_b64_tr_b16 v[54:55], v14 offset:57856
    s_waitcnt lgkmcnt(8)
    v_mfma_f32_16x16x32_bf16 v[96:99], v[32:35], v[128:131], 0
    ds_read_b64_tr_b16 v[56:57], v14 offset:51200
    v_mfma_f32_16x16x32_bf16 v[96:99], v[36:39], v[136:139], v[96:99]
    ds_read_b64_tr_b16 v[58:59], v14 offset:51712
    v_mfma_f32_16x16x32_bf16 v[100:103], v[36:39], v[140:143], 0
    ds_read_b64_tr_b16 v[60:61], v14 offset:59392
    v_mfma_f32_16x16x32_bf16 v[100:103], v[32:35], v[132:135], v[100:103]
    ds_read_b64_tr_b16 v[62:63], v14 offset:59904
    s_waitcnt lgkmcnt(8)
    v_mfma_f32_16x16x32_bf16 v[108:111], v[40:43], v[132:135], 0
L_stub2:
    s_cbranch_execz L_stub6
    ds_read_b64_tr_b16 v[32:33], v15 offset:32768
    v_xor_b32 v14, 196608, v14
    v_mfma_f32_16x16x32_bf16 v[108:111], v[44:47], v[140:143], v[108:111]
    ds_read_b64_tr_b16 v[34:35], v15 offset:33280
    v_mfma_f32_16x16x32_bf16 v[104:107], v[44:47], v[136:139], 0
    ds_read_b64_tr_b16 v[36:37], v15 offset:40960
    v_mfma_f32_16x16x32_bf16 v[104:107], v[40:43], v[128:131], v[104:107]
    ds_read_b64_tr_b16 v[38:39], v15 offset:41472
    s_waitcnt lgkmcnt(8)
    v_mfma_f32_16x16x32_bf16 v[96:99], v[48:51], v[144:147], v[96:99]
    ds_read_b64_tr_b16 v[40:41], v15 offset:34816
    v_mfma_f32_16x16x32_bf16 v[96:99], v[52:55], v[152:155], v[96:99]
    ds_read_b64_tr_b16 v[42:43], v15 offset:35328
    v_mfma_f32_16x16x32_bf16 v[100:103], v[52:55], v[156:159], v[100:103]
    ds_read_b64_tr_b16 v[44:45], v15 offset:43008
    v_mfma_f32_16x16x32_bf16 v[100:103], v[48:51], v[148:151], v[100:103]
    ds_read_b64_tr_b16 v[46:47], v15 offset:43520
    s_waitcnt lgkmcnt(8)
    v_mfma_f32_16x16x32_bf16 v[108:111], v[56:59], v[148:151], v[108:111]
    ds_read_b64_tr_b16 v[48:49], v15 offset:49152
    v_mfma_f32_16x16x32_bf16 v[108:111], v[60:63], v[156:159], v[108:111]
    ds_read_b64_tr_b16 v[50:51], v15 offset:49664
    v_mfma_f32_16x16x32_bf16 v[104:107], v[60:63], v[152:155], v[104:107]
    ds_read_b64_tr_b16 v[52:53], v15 offset:57344
    v_mfma_f32_16x16x32_bf16 v[104:107], v[56:59], v[144:147], v[104:107]
    ds_read_b64_tr_b16 v[54:55], v15 offset:57856
    s_waitcnt lgkmcnt(8)
    v_mfma_f32_16x16x32_bf16 v[112:115], v[32:35], v[128:131], 0
    ds_read_b64_tr_b16 v[56:57], v15 offset:51200
    v_mfma_f32_16x16x32_bf16 v[112:115], v[36:39], v[136:139], v[112:115]
    ds_read_b64_tr_b16 v[58:59], v15 offset:51712
    v_mfma_f32_16x16x32_bf16 v[116:119], v[36:39], v[140:143], 0
    ds_read_b64_tr_b16 v[60:61], v15 offset:59392
    v_mfma_f32_16x16x32_bf16 v[116:119], v[32:35], v[132:135], v[116:119]
    ds_read_b64_tr_b16 v[62:63], v15 offset:59904
    s_waitcnt lgkmcnt(8)
    v_mfma_f32_16x16x32_bf16 v[124:127], v[40:43], v[132:135], 0
    ds_read_b64_tr_b16 v[32:33], v12 offset:0
    v_xor_b32 v15, 196608, v15
    v_mfma_f32_16x16x32_bf16 v[124:127], v[44:47], v[140:143], v[124:127]
    ds_read_b64_tr_b16 v[34:35], v12 offset:512
    v_mfma_f32_16x16x32_bf16 v[120:123], v[44:47], v[136:139], 0
    ds_read_b64_tr_b16 v[36:37], v12 offset:8192
    v_mfma_f32_16x16x32_bf16 v[120:123], v[40:43], v[128:131], v[120:123]
    ds_read_b64_tr_b16 v[38:39], v12 offset:8704
    s_waitcnt lgkmcnt(8)
    v_mfma_f32_16x16x32_bf16 v[112:115], v[48:51], v[144:147], v[112:115]
    ds_read_b64_tr_b16 v[40:41], v12 offset:2048
    v_mfma_f32_16x16x32_bf16 v[112:115], v[52:55], v[152:155], v[112:115]
    ds_read_b64_tr_b16 v[42:43], v12 offset:2560
    v_mfma_f32_16x16x32_bf16 v[116:119], v[52:55], v[156:159], v[116:119]
    ds_read_b64_tr_b16 v[44:45], v12 offset:10240
    v_mfma_f32_16x16x32_bf16 v[116:119], v[48:51], v[148:151], v[116:119]
    ds_read_b64_tr_b16 v[46:47], v12 offset:10752
    s_waitcnt lgkmcnt(8)
    v_mfma_f32_16x16x32_bf16 v[124:127], v[56:59], v[148:151], v[124:127]
    ds_read_b64_tr_b16 v[48:49], v13 offset:0
    v_mfma_f32_16x16x32_bf16 v[124:127], v[60:63], v[156:159], v[124:127]
    ds_read_b64_tr_b16 v[50:51], v13 offset:512
    v_mfma_f32_16x16x32_bf16 v[120:123], v[60:63], v[152:155], v[120:123]
    ds_read_b64_tr_b16 v[52:53], v13 offset:8192
    v_mfma_f32_16x16x32_bf16 v[120:123], v[56:59], v[144:147], v[120:123]
    ds_read_b64_tr_b16 v[54:55], v13 offset:8704
    s_waitcnt lgkmcnt(8)
    v_mfma_f32_16x16x32_bf16 v[64:67], v[32:35], v[160:163], v[64:67]
    ds_read_b64_tr_b16 v[56:57], v13 offset:2048
    v_mfma_f32_16x16x32_bf16 v[64:67], v[36:39], v[168:171], v[64:67]
    ds_read_b64_tr_b16 v[58:59], v13 offset:2560
    v_mfma_f32_16x16x32_bf16 v[68:71], v[36:39], v[172:175], v[68:71]
    ds_read_b64_tr_b16 v[60:61], v13 offset:10240
    v_mfma_f32_16x16x32_bf16 v[68:71], v[32:35], v[164:167], v[68:71]
    ds_read_b64_tr_b16 v[62:63], v13 offset:10752
    s_waitcnt lgkmcnt(8)
    v_mfma_f32_16x16x32_bf16 v[76:79], v[40:43], v[164:167], v[76:79]
    ds_read_b64_tr_b16 v[32:33], v14 offset:0
    v_mfma_f32_16x16x32_bf16 v[76:79], v[44:47], v[172:175], v[76:79]
    ds_read_b64_tr_b16 v[34:35], v14 offset:512
    v_mfma_f32_16x16x32_bf16 v[72:75], v[44:47], v[168:171], v[72:75]
    ds_read_b64_tr_b16 v[36:37], v14 offset:8192
    v_mfma_f32_16x16x32_bf16 v[72:75], v[40:43], v[160:163], v[72:75]
    ds_read_b64_tr_b16 v[38:39], v14 offset:8704
    s_waitcnt lgkmcnt(8)
    v_mfma_f32_16x16x32_bf16 v[80:83], v[48:51], v[160:163], v[80:83]
    ds_read_b64_tr_b16 v[40:41], v14 offset:2048
    v_mfma_f32_16x16x32_bf16 v[80:83], v[52:55], v[168:171], v[80:83]
    ds_read_b64_tr_b16 v[42:43], v14 offset:2560
    v_mfma_f32_16x16x32_bf16 v[84:87], v[52:55], v[172:175], v[84:87]
    ds_read_b64_tr_b16 v[44:45], v14 offset:10240
    v_mfma_f32_16x16x32_bf16 v[84:87], v[48:51], v[164:167], v[84:87]
    ds_read_b64_tr_b16 v[46:47], v14 offset:10752
    s_waitcnt lgkmcnt(8)
    v_mfma_f32_16x16x32_bf16 v[92:95], v[56:59], v[164:167], v[92:95]
    ds_read_b64_tr_b16 v[48:49], v15 offset:0
    v_mfma_f32_16x16x32_bf16 v[92:95], v[60:63], v[172:175], v[92:95]
    ds_read_b64_tr_b16 v[50:51], v15 offset:512
    v_mfma_f32_16x16x32_bf16 v[88:91], v[60:63], v[168:171], v[88:91]
    ds_read_b64_tr_b16 v[52:53], v15 offset:8192
    v_mfma_f32_16x16x32_bf16 v[88:91], v[56:59], v[160:163], v[88:91]
    ds_read_b64_tr_b16 v[54:55], v15 offset:8704
    s_waitcnt lgkmcnt(8)
    v_mfma_f32_16x16x32_bf16 v[96:99], v[32:35], v[160:163], v[96:99]
    ds_read_b64_tr_b16 v[56:57], v15 offset:2048
    v_mfma_f32_16x16x32_bf16 v[96:99], v[36:39], v[168:171], v[96:99]
    ds_read_b64_tr_b16 v[58:59], v15 offset:2560
    v_mfma_f32_16x16x32_bf16 v[100:103], v[36:39], v[172:175], v[100:103]
    ds_read_b64_tr_b16 v[60:61], v15 offset:10240
    v_mfma_f32_16x16x32_bf16 v[100:103], v[32:35], v[164:167], v[100:103]
    ds_read_b64_tr_b16 v[62:63], v15 offset:10752
    s_waitcnt lgkmcnt(8)
    v_mfma_f32_16x16x32_bf16 v[108:111], v[40:43], v[164:167], v[108:111]
    ds_read_b64_tr_b16 v[32:33], v12 offset:16384
    v_mfma_f32_16x16x32_bf16 v[108:111], v[44:47], v[172:175], v[108:111]
    ds_read_b64_tr_b16 v[34:35], v12 offset:16896
    v_mfma_f32_16x16x32_bf16 v[104:107], v[44:47], v[168:171], v[104:107]
    ds_read_b64_tr_b16 v[36:37], v12 offset:24576
    v_mfma_f32_16x16x32_bf16 v[104:107], v[40:43], v[160:163], v[104:107]
    ds_read_b64_tr_b16 v[38:39], v12 offset:25088
    s_waitcnt lgkmcnt(8)
    v_mfma_f32_16x16x32_bf16 v[112:115], v[48:51], v[160:163], v[112:115]
    ds_read_b64_tr_b16 v[40:41], v12 offset:18432
    v_mfma_f32_16x16x32_bf16 v[112:115], v[52:55], v[168:171], v[112:115]
    ds_read_b64_tr_b16 v[42:43], v12 offset:18944
    v_mfma_f32_16x16x32_bf16 v[116:119], v[52:55], v[172:175], v[116:119]
    ds_read_b64_tr_b16 v[44:45], v12 offset:26624
    v_mfma_f32_16x16x32_bf16 v[116:119], v[48:51], v[164:167], v[116:119]
    ds_read_b64_tr_b16 v[46:47], v12 offset:27136
    v_xor_b32 v12, 131072, v12
    s_waitcnt lgkmcnt(8)
    v_mfma_f32_16x16x32_bf16 v[124:127], v[56:59], v[164:167], v[124:127]
    ds_read_b64_tr_b16 v[48:49], v13 offset:16384
    s_waitcnt vmcnt(0)
    v_mov_b32 v7, 1
    s_mov_b64 exec, 1
    buffer_store_dword v7, off, s[32:35], s57 sc1
    s_mov_b64 exec, -1
    v_mfma_f32_16x16x32_bf16 v[124:127], v[60:63], v[172:175], v[124:127]
    ds_read_b64_tr_b16 v[50:51], v13 offset:16896
    v_mfma_f32_16x16x32_bf16 v[120:123], v[60:63], v[168:171], v[120:123]
    ds_read_b64_tr_b16 v[52:53], v13 offset:24576
    v_mfma_f32_16x16x32_bf16 v[120:123], v[56:59], v[160:163], v[120:123]
    ds_read_b64_tr_b16 v[54:55], v13 offset:25088
    s_waitcnt lgkmcnt(8)
    v_mfma_f32_16x16x32_bf16 v[64:67], v[32:35], v[176:179], v[64:67]
    ds_read_b64_tr_b16 v[56:57], v13 offset:18432
    v_mfma_f32_16x16x32_bf16 v[64:67], v[36:39], v[184:187], v[64:67]
    ds_read_b64_tr_b16 v[58:59], v13 offset:18944
    v_mfma_f32_16x16x32_bf16 v[68:71], v[36:39], v[188:191], v[68:71]
    ds_read_b64_tr_b16 v[60:61], v13 offset:26624
    v_mfma_f32_16x16x32_bf16 v[68:71], v[32:35], v[180:183], v[68:71]
    ds_read_b64_tr_b16 v[62:63], v13 offset:27136
    s_waitcnt lgkmcnt(8)
    v_mfma_f32_16x16x32_bf16 v[76:79], v[40:43], v[180:183], v[76:79]
    ds_read_b64_tr_b16 v[32:33], v14 offset:16384
    v_xor_b32 v13, 131072, v13
    v_mfma_f32_16x16x32_bf16 v[76:79], v[44:47], v[188:191], v[76:79]
    ds_read_b64_tr_b16 v[34:35], v14 offset:16896
    v_mfma_f32_16x16x32_bf16 v[72:75], v[44:47], v[184:187], v[72:75]
    ds_read_b64_tr_b16 v[36:37], v14 offset:24576
    v_mfma_f32_16x16x32_bf16 v[72:75], v[40:43], v[176:179], v[72:75]
    ds_read_b64_tr_b16 v[38:39], v14 offset:25088
    s_waitcnt lgkmcnt(8)
    v_mfma_f32_16x16x32_bf16 v[80:83], v[48:51], v[176:179], v[80:83]
    ds_read_b64_tr_b16 v[40:41], v14 offset:18432
    v_mfma_f32_16x16x32_bf16 v[80:83], v[52:55], v[184:187], v[80:83]
    ds_read_b64_tr_b16 v[42:43], v14 offset:18944
    v_mfma_f32_16x16x32_bf16 v[84:87], v[52:55], v[188:191], v[84:87]
    ds_read_b64_tr_b16 v[44:45], v14 offset:26624
    v_mfma_f32_16x16x32_bf16 v[84:87], v[48:51], v[180:183], v[84:87]
    ds_read_b64_tr_b16 v[46:47], v14 offset:27136
    s_waitcnt lgkmcnt(8)
    v_mfma_f32_16x16x32_bf16 v[92:95], v[56:59], v[180:183], v[92:95]
    ds_read_b64_tr_b16 v[48:49], v15 offset:16384
    v_xor_b32 v14, 131072, v14
    v_mfma_f32_16x16x32_bf16 v[92:95], v[60:63], v[188:191], v[92:95]
    ds_read_b64_tr_b16 v[50:51], v15 offset:16896
    v_mfma_f32_16x16x32_bf16 v[88:91], v[60:63], v[184:187], v[88:91]
    ds_read_b64_tr_b16 v[52:53], v15 offset:24576
    v_mfma_f32_16x16x32_bf16 v[88:91], v[56:59], v[176:179], v[88:91]
    ds_read_b64_tr_b16 v[54:55], v15 offset:25088
    s_waitcnt lgkmcnt(8)
    v_mfma_f32_16x16x32_bf16 v[96:99], v[32:35], v[176:179], v[96:99]
    ds_read_b64_tr_b16 v[56:57], v15 offset:18432
    v_mfma_f32_16x16x32_bf16 v[96:99], v[36:39], v[184:187], v[96:99]
    ds_read_b64_tr_b16 v[58:59], v15 offset:18944
    s_barrier
    v_mfma_f32_16x16x32_bf16 v[100:103], v[36:39], v[188:191], v[100:103]
    ds_read_b64_tr_b16 v[60:61], v15 offset:26624
    v_mfma_f32_16x16x32_bf16 v[100:103], v[32:35], v[180:183], v[100:103]
    ds_read_b64_tr_b16 v[62:63], v15 offset:27136
    s_waitcnt lgkmcnt(8)
    v_mfma_f32_16x16x32_bf16 v[108:111], v[40:43], v[180:183], v[108:111]
    ds_read_b64_tr_b16 v[32:33], v12 offset:0
    v_xor_b32 v15, 131072, v15
    v_mfma_f32_16x16x32_bf16 v[108:111], v[44:47], v[188:191], v[108:111]
    ds_read_b64_tr_b16 v[34:35], v12 offset:512
    v_mfma_f32_16x16x32_bf16 v[104:107], v[44:47], v[184:187], v[104:107]
    ds_read_b64_tr_b16 v[36:37], v12 offset:8192
    v_mfma_f32_16x16x32_bf16 v[104:107], v[40:43], v[176:179], v[104:107]
    ds_read_b64_tr_b16 v[38:39], v12 offset:8704
    s_waitcnt lgkmcnt(8)
    v_mfma_f32_16x16x32_bf16 v[112:115], v[48:51], v[176:179], v[112:115]
    ds_read_b64_tr_b16 v[40:41], v12 offset:2048
    v_mfma_f32_16x16x32_bf16 v[112:115], v[52:55], v[184:187], v[112:115]
    ds_read_b64_tr_b16 v[42:43], v12 offset:2560
    v_mfma_f32_16x16x32_bf16 v[116:119], v[52:55], v[188:191], v[116:119]
    ds_read_b64_tr_b16 v[44:45], v12 offset:10240
    v_mfma_f32_16x16x32_bf16 v[116:119], v[48:51], v[180:183], v[116:119]
    ds_read_b64_tr_b16 v[46:47], v12 offset:10752
    s_waitcnt lgkmcnt(8)
    v_mfma_f32_16x16x32_bf16 v[124:127], v[56:59], v[180:183], v[124:127]
    ds_read_b64_tr_b16 v[48:49], v13 offset:0
    v_mfma_f32_16x16x32_bf16 v[124:127], v[60:63], v[188:191], v[124:127]
    ds_read_b64_tr_b16 v[50:51], v13 offset:512
    v_mfma_f32_16x16x32_bf16 v[120:123], v[60:63], v[184:187], v[120:123]
    ds_read_b64_tr_b16 v[52:53], v13 offset:8192
    v_mfma_f32_16x16x32_bf16 v[120:123], v[56:59], v[176:179], v[120:123]
    ds_read_b64_tr_b16 v[54:55], v13 offset:8704
    s_waitcnt lgkmcnt(8)
    v_mfma_f32_16x16x32_bf16 v[64:67], v[32:35], v[192:195], v[64:67]
    ds_read_b64_tr_b16 v[56:57], v13 offset:2048
    v_mfma_f32_16x16x32_bf16 v[64:67], v[36:39], v[200:203], v[64:67]
    ds_read_b64_tr_b16 v[58:59], v13 offset:2560
    v_mfma_f32_16x16x32_bf16 v[68:71], v[36:39], v[204:207], v[68:71]
    ds_read_b64_tr_b16 v[60:61], v13 offset:10240
    v_mfma_f32_16x16x32_bf16 v[68:71], v[32:35], v[196:199], v[68:71]
    ds_read_b64_tr_b16 v[62:63], v13 offset:10752
    s_waitcnt lgkmcnt(8)
    v_mfma_f32_16x16x32_bf16 v[76:79], v[40:43], v[196:199], v[76:79]
    ds_read_b64_tr_b16 v[32:33], v12 offset:16384
    v_mfma_f32_16x16x32_bf16 v[76:79], v[44:47], v[204:207], v[76:79]
    ds_read_b64_tr_b16 v[34:35], v12 offset:16896
    v_mfma_f32_16x16x32_bf16 v[72:75], v[44:47], v[200:203], v[72:75]
    ds_read_b64_tr_b16 v[36:37], v12 offset:24576
    v_mfma_f32_16x16x32_bf16 v[72:75], v[40:43], v[192:195], v[72:75]
    ds_read_b64_tr_b16 v[38:39], v12 offset:25088
    s_waitcnt lgkmcnt(8)
    v_mfma_f32_16x16x32_bf16 v[80:83], v[48:51], v[192:195], v[80:83]
    ds_read_b64_tr_b16 v[40:41], v12 offset:18432
    v_mfma_f32_16x16x32_bf16 v[80:83], v[52:55], v[200:203], v[80:83]
    ds_read_b64_tr_b16 v[42:43], v12 offset:18944
    v_mfma_f32_16x16x32_bf16 v[84:87], v[52:55], v[204:207], v[84:87]
    ds_read_b64_tr_b16 v[44:45], v12 offset:26624
    v_mfma_f32_16x16x32_bf16 v[84:87], v[48:51], v[196:199], v[84:87]
    ds_read_b64_tr_b16 v[46:47], v12 offset:27136
    s_waitcnt lgkmcnt(8)
    v_mfma_f32_16x16x32_bf16 v[92:95], v[56:59], v[196:199], v[92:95]
    ds_read_b64_tr_b16 v[48:49], v13 offset:16384
    v_mfma_f32_16x16x32_bf16 v[92:95], v[60:63], v[204:207], v[92:95]
    ds_read_b64_tr_b16 v[50:51], v13 offset:16896
    v_mfma_f32_16x16x32_bf16 v[88:91], v[60:63], v[200:203], v[88:91]
    ds_read_b64_tr_b16 v[52:53], v13 offset:24576
    v_mfma_f32_16x16x32_bf16 v[88:91], v[56:59], v[192:195], v[88:91]
    ds_read_b64_tr_b16 v[54:55], v13 offset:25088
    s_waitcnt lgkmcnt(8)
    v_mfma_f32_16x16x32_bf16 v[64:67], v[32:35], v[208:211], v[64:67]
    ds_read_b64_tr_b16 v[56:57], v13 offset:18432
    v_mfma_f32_16x16x32_bf16 v[64:67], v[36:39], v[216:219], v[64:67]
    ds_read_b64_tr_b16 v[58:59], v13 offset:18944
    v_mfma_f32_16x16x32_bf16 v[68:71], v[36:39], v[220:223], v[68:71]
    ds_read_b64_tr_b16 v[60:61], v13 offset:26624
    v_mfma_f32_16x16x32_bf16 v[68:71], v[32:35], v[212:215], v[68:71]
    ds_read_b64_tr_b16 v[62:63], v13 offset:27136
    s_waitcnt lgkmcnt(8)
    v_mfma_f32_16x16x32_bf16 v[76:79], v[40:43], v[212:215], v[76:79]
    ds_read_b64_tr_b16 v[32:33], v12 offset:32768
    v_mfma_f32_16x16x32_bf16 v[76:79], v[44:47], v[220:223], v[76:79]
    ds_read_b64_tr_b16 v[34:35], v12 offset:33280
    v_mfma_f32_16x16x32_bf16 v[72:75], v[44:47], v[216:219], v[72:75]
    ds_read_b64_tr_b16 v[36:37], v12 offset:40960
    v_mfma_f32_16x16x32_bf16 v[72:75], v[40:43], v[208:211], v[72:75]
    ds_read_b64_tr_b16 v[38:39], v12 offset:41472
    s_waitcnt lgkmcnt(8)
    v_mfma_f32_16x16x32_bf16 v[80:83], v[48:51], v[208:211], v[80:83]
L_stub3:
    s_cbranch_execz L_warmed
    ds_read_b64_tr_b16 v[40:41], v12 offset:34816
    v_mfma_f32_16x16x32_bf16 v[80:83], v[52:55], v[216:219], v[80:83]
    ds_read_b64_tr_b16 v[42:43], v12 offset:35328
    v_mfma_f32_16x16x32_bf16 v[84:87], v[52:55], v[220:223], v[84:87]
    ds_read_b64_tr_b16 v[44:45], v12 offset:43008
    v_mfma_f32_16x16x32_bf16 v[84:87], v[48:51], v[212:215], v[84:87]
    ds_read_b64_tr_b16 v[46:47], v12 offset:43520
    s_waitcnt lgkmcnt(8)
    v_mfma_f32_16x16x32_bf16 v[92:95], v[56:59], v[212:215], v[92:95]
    ds_read_b64_tr_b16 v[48:49], v13 offset:32768
    v_mfma_f32_16x16x32_bf16 v[92:95], v[60:63], v[220:223], v[92:95]
    ds_read_b64_tr_b16 v[50:51], v13 offset:33280
    v_mfma_f32_16x16x32_bf16 v[88:91], v[60:63], v[216:219], v[88:91]
    ds_read_b64_tr_b16 v[52:53], v13 offset:40960
    v_mfma_f32_16x16x32_bf16 v[88:91], v[56:59], v[208:211], v[88:91]
    ds_read_b64_tr_b16 v[54:55], v13 offset:41472
    s_waitcnt lgkmcnt(8)
    v_mfma_f32_16x16x32_bf16 v[64:67], v[32:35], v[224:227], v[64:67]
    ds_read_b64_tr_b16 v[56:57], v13 offset:34816
    v_mfma_f32_16x16x32_bf16 v[64:67], v[36:39], v[232:235], v[64:67]
    ds_read_b64_tr_b16 v[58:59], v13 offset:35328
    v_mfma_f32_16x16x32_bf16 v[68:71], v[36:39], v[236:239], v[68:71]
    ds_read_b64_tr_b16 v[60:61], v13 offset:43008
    v_mfma_f32_16x16x32_bf16 v[68:71], v[32:35], v[228:231], v[68:71]
    ds_read_b64_tr_b16 v[62:63], v13 offset:43520
    s_waitcnt lgkmcnt(8)
    v_mfma_f32_16x16x32_bf16 v[76:79], v[40:43], v[228:231], v[76:79]
    ds_read_b64_tr_b16 v[32:33], v12 offset:49152
    v_mfma_f32_16x16x32_bf16 v[76:79], v[44:47], v[236:239], v[76:79]
    ds_read_b64_tr_b16 v[34:35], v12 offset:49664
    v_mfma_f32_16x16x32_bf16 v[72:75], v[44:47], v[232:235], v[72:75]
    ds_read_b64_tr_b16 v[36:37], v12 offset:57344
    v_mfma_f32_16x16x32_bf16 v[72:75], v[40:43], v[224:227], v[72:75]
    ds_read_b64_tr_b16 v[38:39], v12 offset:57856
    s_waitcnt lgkmcnt(8)
    v_mfma_f32_16x16x32_bf16 v[80:83], v[48:51], v[224:227], v[80:83]
    ds_read_b64_tr_b16 v[40:41], v12 offset:51200
    v_mfma_f32_16x16x32_bf16 v[80:83], v[52:55], v[232:235], v[80:83]
    ds_read_b64_tr_b16 v[42:43], v12 offset:51712
    v_mfma_f32_16x16x32_bf16 v[84:87], v[52:55], v[236:239], v[84:87]
    ds_read_b64_tr_b16 v[44:45], v12 offset:59392
    v_mfma_f32_16x16x32_bf16 v[84:87], v[48:51], v[228:231], v[84:87]
    ds_read_b64_tr_b16 v[46:47], v12 offset:59904
    s_waitcnt lgkmcnt(8)
    v_mfma_f32_16x16x32_bf16 v[92:95], v[56:59], v[228:231], v[92:95]
    ds_read_b64_tr_b16 v[48:49], v13 offset:49152
    v_mfma_f32_16x16x32_bf16 v[92:95], v[60:63], v[236:239], v[92:95]
    ds_read_b64_tr_b16 v[50:51], v13 offset:49664
    v_mfma_f32_16x16x32_bf16 v[88:91], v[60:63], v[232:235], v[88:91]
    ds_read_b64_tr_b16 v[52:53], v13 offset:57344
    v_mfma_f32_16x16x32_bf16 v[88:91], v[56:59], v[224:227], v[88:91]
    ds_read_b64_tr_b16 v[54:55], v13 offset:57856
    s_waitcnt lgkmcnt(8)
    v_mfma_f32_16x16x32_bf16 v[64:67], v[32:35], v[240:243], v[64:67]
    ds_read_b64_tr_b16 v[56:57], v13 offset:51200
    v_mfma_f32_16x16x32_bf16 v[64:67], v[36:39], v[248:251], v[64:67]
    ds_read_b64_tr_b16 v[58:59], v13 offset:51712
    v_mfma_f32_16x16x32_bf16 v[68:71], v[36:39], v[252:255], v[68:71]
    ds_read_b64_tr_b16 v[60:61], v13 offset:59392
    v_mfma_f32_16x16x32_bf16 v[68:71], v[32:35], v[244:247], v[68:71]
    ds_read_b64_tr_b16 v[62:63], v13 offset:59904
    s_waitcnt lgkmcnt(8)
    v_mfma_f32_16x16x32_bf16 v[76:79], v[40:43], v[244:247], v[76:79]
    ds_read_b64_tr_b16 v[32:33], v14 offset:0
    v_mfma_f32_16x16x32_bf16 v[76:79], v[44:47], v[252:255], v[76:79]
    ds_read_b64_tr_b16 v[34:35], v14 offset:512
    v_mfma_f32_16x16x32_bf16 v[72:75], v[44:47], v[248:251], v[72:75]
    ds_read_b64_tr_b16 v[36:37], v14 offset:8192
    v_mfma_f32_16x16x32_bf16 v[72:75], v[40:43], v[240:243], v[72:75]
    ds_read_b64_tr_b16 v[38:39], v14 offset:8704
    s_waitcnt lgkmcnt(8)
    v_mfma_f32_16x16x32_bf16 v[80:83], v[48:51], v[240:243], v[80:83]
    ds_read_b64_tr_b16 v[40:41], v14 offset:2048
    v_mfma_f32_16x16x32_bf16 v[80:83], v[52:55], v[248:251], v[80:83]
    ds_read_b64_tr_b16 v[42:43], v14 offset:2560
    v_mfma_f32_16x16x32_bf16 v[84:87], v[52:55], v[252:255], v[84:87]
    ds_read_b64_tr_b16 v[44:45], v14 offset:10240
    v_mfma_f32_16x16x32_bf16 v[84:87], v[48:51], v[244:247], v[84:87]
    ds_read_b64_tr_b16 v[46:47], v14 offset:10752
    s_waitcnt lgkmcnt(8)
    v_mfma_f32_16x16x32_bf16 v[92:95], v[56:59], v[244:247], v[92:95]
    ds_read_b64_tr_b16 v[48:49], v14 offset:16384
    v_mfma_f32_16x16x32_bf16 v[92:95], v[60:63], v[252:255], v[92:95]
    ds_read_b64_tr_b16 v[50:51], v14 offset:16896
    v_mul_f32 v64, v64, v72
    v_mfma_f32_16x16x32_bf16 v[88:91], v[60:63], v[248:251], v[88:91]
    ds_read_b64_tr_b16 v[52:53], v14 offset:24576
    v_mul_f32 v65, v65, v73
    v_mfma_f32_16x16x32_bf16 v[88:91], v[56:59], v[240:243], v[88:91]
    ds_read_b64_tr_b16 v[54:55], v14 offset:25088
    v_cvt_pk_bf16_f32 v16, v64, v65
    s_waitcnt lgkmcnt(8)
    v_mfma_f32_16x16x32_bf16 v[96:99], v[32:35], v[192:195], v[96:99]
    ds_read_b64_tr_b16 v[56:57], v14 offset:18432
    v_mul_f32 v66, v66, v74
    v_mfma_f32_16x16x32_bf16 v[96:99], v[36:39], v[200:203], v[96:99]
    ds_read_b64_tr_b16 v[58:59], v14 offset:18944
    v_mul_f32 v67, v67, v75
    v_mfma_f32_16x16x32_bf16 v[100:103], v[36:39], v[204:207], v[100:103]
    ds_read_b64_tr_b16 v[60:61], v14 offset:26624
    v_cvt_pk_bf16_f32 v17, v66, v67
    v_mfma_f32_16x16x32_bf16 v[100:103], v[32:35], v[196:199], v[100:103]
    ds_read_b64_tr_b16 v[62:63], v14 offset:27136
    v_mul_f32 v68, v68, v76
    s_waitcnt lgkmcnt(8)
    v_mfma_f32_16x16x32_bf16 v[108:111], v[40:43], v[196:199], v[108:111]
    ds_read_b64_tr_b16 v[32:33], v14 offset:32768
    v_mul_f32 v69, v69, v77
    v_mfma_f32_16x16x32_bf16 v[108:111], v[44:47], v[204:207], v[108:111]
    ds_read_b64_tr_b16 v[34:35], v14 offset:33280
    v_cvt_pk_bf16_f32 v20, v68, v69
    v_mfma_f32_16x16x32_bf16 v[104:107], v[44:47], v[200:203], v[104:107]
    ds_read_b64_tr_b16 v[36:37], v14 offset:40960
    v_mul_f32 v70, v70, v78
    v_mfma_f32_16x16x32_bf16 v[104:107], v[40:43], v[192:195], v[104:107]
    ds_read_b64_tr_b16 v[38:39], v14 offset:41472
    v_mul_f32 v71, v71, v79
    s_waitcnt lgkmcnt(8)
    v_mfma_f32_16x16x32_bf16 v[96:99], v[48:51], v[208:211], v[96:99]
    ds_read_b64_tr_b16 v[40:41], v14 offset:34816
    v_cvt_pk_bf16_f32 v21, v70, v71
    v_mfma_f32_16x16x32_bf16 v[96:99], v[52:55], v[216:219], v[96:99]
    ds_read_b64_tr_b16 v[42:43], v14 offset:35328
    v_mul_f32 v80, v80, v88
    v_mfma_f32_16x16x32_bf16 v[100:103], v[52:55], v[220:223], v[100:103]
    ds_read_b64_tr_b16 v[44:45], v14 offset:43008
    v_mul_f32 v81, v81, v89
    v_mfma_f32_16x16x32_bf16 v[100:103], v[48:51], v[212:215], v[100:103]
    ds_read_b64_tr_b16 v[46:47], v14 offset:43520
    v_cvt_pk_bf16_f32 v18, v80, v81
    s_waitcnt lgkmcnt(8)
    v_mfma_f32_16x16x32_bf16 v[108:111], v[56:59], v[212:215], v[108:111]
    ds_read_b64_tr_b16 v[48:49], v14 offset:49152
    v_mul_f32 v82, v82, v90
    v_mfma_f32_16x16x32_bf16 v[108:111], v[60:63], v[220:223], v[108:111]
    ds_read_b64_tr_b16 v[50:51], v14 offset:49664
    v_mul_f32 v83, v83, v91
    v_mfma_f32_16x16x32_bf16 v[104:107], v[60:63], v[216:219], v[104:107]
    ds_read_b64_tr_b16 v[52:53], v14 offset:57344
    v_cvt_pk_bf16_f32 v19, v82, v83
    v_mfma_f32_16x16x32_bf16 v[104:107], v[56:59], v[208:211], v[104:107]
    ds_read_b64_tr_b16 v[54:55], v14 offset:57856
    v_mul_f32 v84, v84, v92
    v_mul_f32 v85, v85, v93
    s_waitcnt lgkmcnt(8)
    v_mfma_f32_16x16x32_bf16 v[96:99], v[32:35], v[224:227], v[96:99]
    ds_read_b64_tr_b16 v[56:57], v14 offset:51200
    buffer_store_dwordx4 v[16:19], v6, s[32:35], s61 offen offset:0 sc1
    v_mfma_f32_16x16x32_bf16 v[96:99], v[36:39], v[232:235], v[96:99]
    ds_read_b64_tr_b16 v[58:59], v14 offset:51712
    v_cvt_pk_bf16_f32 v22, v84, v85
    v_mfma_f32_16x16x32_bf16 v[100:103], v[36:39], v[236:239], v[100:103]
    ds_read_b64_tr_b16 v[60:61], v14 offset:59392
    v_mul_f32 v86, v86, v94
    v_mfma_f32_16x16x32_bf16 v[100:103], v[32:35], v[228:231], v[100:103]
    ds_read_b64_tr_b16 v[62:63], v14 offset:59904
    v_mul_f32 v87, v87, v95
    s_waitcnt lgkmcnt(8)
    v_mfma_f32_16x16x32_bf16 v[108:111], v[40:43], v[228:231], v[108:111]
    ds_read_b64_tr_b16 v[32:33], v15 offset:0
    v_cvt_pk_bf16_f32 v23, v86, v87
    v_mfma_f32_16x16x32_bf16 v[108:111], v[44:47], v[236:239], v[108:111]
    ds_read_b64_tr_b16 v[34:35], v15 offset:512
    buffer_store_dwordx4 v[20:23], v6, s[32:35], s61 offen offset:1024 sc1
    v_mfma_f32_16x16x32_bf16 v[104:107], v[44:47], v[232:235], v[104:107]
    ds_read_b64_tr_b16 v[36:37], v15 offset:8192
    v_mfma_f32_16x16x32_bf16 v[104:107], v[40:43], v[224:227], v[104:107]
    ds_read_b64_tr_b16 v[38:39], v15 offset:8704
    s_waitcnt lgkmcnt(8)
    v_mfma_f32_16x16x32_bf16 v[96:99], v[48:51], v[240:243], v[96:99]
    ds_read_b64_tr_b16 v[40:41], v15 offset:2048
    v_mfma_f32_16x16x32_bf16 v[96:99], v[52:55], v[248:251], v[96:99]
    ds_read_b64_tr_b16 v[42:43], v15 offset:2560
    v_mfma_f32_16x16x32_bf16 v[100:103], v[52:55], v[252:255], v[100:103]
    ds_read_b64_tr_b16 v[44:45], v15 offset:10240
    v_mfma_f32_16x16x32_bf16 v[100:103], v[48:51], v[244:247], v[100:103]
    ds_read_b64_tr_b16 v[46:47], v15 offset:10752
    s_waitcnt lgkmcnt(8)
    v_mfma_f32_16x16x32_bf16 v[108:111], v[56:59], v[244:247], v[108:111]
    ds_read_b64_tr_b16 v[48:49], v15 offset:16384
    v_mfma_f32_16x16x32_bf16 v[108:111], v[60:63], v[252:255], v[108:111]
    ds_read_b64_tr_b16 v[50:51], v15 offset:16896
    v_mfma_f32_16x16x32_bf16 v[104:107], v[60:63], v[248:251], v[104:107]
    ds_read_b64_tr_b16 v[52:53], v15 offset:24576
    v_mfma_f32_16x16x32_bf16 v[104:107], v[56:59], v[240:243], v[104:107]
    ds_read_b64_tr_b16 v[54:55], v15 offset:25088
    s_waitcnt lgkmcnt(8)
    v_mfma_f32_16x16x32_bf16 v[112:115], v[32:35], v[192:195], v[112:115]
    ds_read_b64_tr_b16 v[56:57], v15 offset:18432
    v_mfma_f32_16x16x32_bf16 v[112:115], v[36:39], v[200:203], v[112:115]
    ds_read_b64_tr_b16 v[58:59], v15 offset:18944
    v_mfma_f32_16x16x32_bf16 v[116:119], v[36:39], v[204:207], v[116:119]
    ds_read_b64_tr_b16 v[60:61], v15 offset:26624
    v_mfma_f32_16x16x32_bf16 v[116:119], v[32:35], v[196:199], v[116:119]
    ds_read_b64_tr_b16 v[62:63], v15 offset:27136
    s_waitcnt lgkmcnt(8)
    v_mfma_f32_16x16x32_bf16 v[124:127], v[40:43], v[196:199], v[124:127]
    ds_read_b64_tr_b16 v[32:33], v15 offset:32768
    v_mfma_f32_16x16x32_bf16 v[124:127], v[44:47], v[204:207], v[124:127]
    ds_read_b64_tr_b16 v[34:35], v15 offset:33280
    v_mul_f32 v96, v96, v104
    v_mfma_f32_16x16x32_bf16 v[120:123], v[44:47], v[200:203], v[120:123]
    ds_read_b64_tr_b16 v[36:37], v15 offset:40960
    v_mul_f32 v97, v97, v105
    v_mfma_f32_16x16x32_bf16 v[120:123], v[40:43], v[192:195], v[120:123]
    ds_read_b64_tr_b16 v[38:39], v15 offset:41472
    v_cvt_pk_bf16_f32 v24, v96, v97
    s_waitcnt lgkmcnt(8)
    v_mfma_f32_16x16x32_bf16 v[112:115], v[48:51], v[208:211], v[112:115]
    ds_read_b64_tr_b16 v[40:41], v15 offset:34816
    v_mul_f32 v98, v98, v106
    v_mfma_f32_16x16x32_bf16 v[112:115], v[52:55], v[216:219], v[112:115]
    ds_read_b64_tr_b16 v[42:43], v15 offset:35328
    v_mul_f32 v99, v99, v107
    v_mfma_f32_16x16x32_bf16 v[116:119], v[52:55], v[220:223], v[116:119]
    ds_read_b64_tr_b16 v[44:45], v15 offset:43008
    v_cvt_pk_bf16_f32 v25, v98, v99
    v_mfma_f32_16x16x32_bf16 v[116:119], v[48:51], v[212:215], v[116:119]
    ds_read_b64_tr_b16 v[46:47], v15 offset:43520
    v_mul_f32 v100, v100, v108
    s_waitcnt lgkmcnt(8)
    v_mfma_f32_16x16x32_bf16 v[124:127], v[56:59], v[212:215], v[124:127]
    ds_read_b64_tr_b16 v[48:49], v15 offset:49152
    v_mul_f32 v101, v101, v109
    v_mfma_f32_16x16x32_bf16 v[124:127], v[60:63], v[220:223], v[124:127]
    ds_read_b64_tr_b16 v[50:51], v15 offset:49664
    v_cvt_pk_bf16_f32 v28, v100, v101
    v_mfma_f32_16x16x32_bf16 v[120:123], v[60:63], v[216:219], v[120:123]
    ds_read_b64_tr_b16 v[52:53], v15 offset:57344
    v_mul_f32 v102, v102, v110
    v_mfma_f32_16x16x32_bf16 v[120:123], v[56:59], v[208:211], v[120:123]
    ds_read_b64_tr_b16 v[54:55], v15 offset:57856
    v_mul_f32 v103, v103, v111
    s_waitcnt lgkmcnt(8)
    v_mfma_f32_16x16x32_bf16 v[112:115], v[32:35], v[224:227], v[112:115]
    ds_read_b64_tr_b16 v[56:57], v15 offset:51200
    v_cvt_pk_bf16_f32 v29, v102, v103
    v_mfma_f32_16x16x32_bf16 v[112:115], v[36:39], v[232:235], v[112:115]
    ds_read_b64_tr_b16 v[58:59], v15 offset:51712
    v_mfma_f32_16x16x32_bf16 v[116:119], v[36:39], v[236:239], v[116:119]
    ds_read_b64_tr_b16 v[60:61], v15 offset:59392
    v_mfma_f32_16x16x32_bf16 v[116:119], v[32:35], v[228:231], v[116:119]
    ds_read_b64_tr_b16 v[62:63], v15 offset:59904
    s_waitcnt lgkmcnt(8)
    v_mfma_f32_16x16x32_bf16 v[124:127], v[40:43], v[228:231], v[124:127]
    v_mfma_f32_16x16x32_bf16 v[124:127], v[44:47], v[236:239], v[124:127]
    v_mfma_f32_16x16x32_bf16 v[120:123], v[44:47], v[232:235], v[120:123]
    v_mfma_f32_16x16x32_bf16 v[120:123], v[40:43], v[224:227], v[120:123]
    s_waitcnt lgkmcnt(4)
    v_mfma_f32_16x16x32_bf16 v[112:115], v[48:51], v[240:243], v[112:115]
    v_mfma_f32_16x16x32_bf16 v[112:115], v[52:55], v[248:251], v[112:115]
    v_mfma_f32_16x16x32_bf16 v[116:119], v[52:55], v[252:255], v[116:119]
    v_mfma_f32_16x16x32_bf16 v[116:119], v[48:51], v[244:247], v[116:119]
    s_waitcnt lgkmcnt(0)
    v_mfma_f32_16x16x32_bf16 v[124:127], v[56:59], v[244:247], v[124:127]
    v_mfma_f32_16x16x32_bf16 v[124:127], v[60:63], v[252:255], v[124:127]
    v_mfma_f32_16x16x32_bf16 v[120:123], v[60:63], v[248:251], v[120:123]
    v_mfma_f32_16x16x32_bf16 v[120:123], v[56:59], v[240:243], v[120:123]
    s_nop 7
    v_mul_f32 v112, v112, v120
    v_mul_f32 v113, v113, v121
    v_cvt_pk_bf16_f32 v26, v112, v113
    v_mul_f32 v114, v114, v122
    v_mul_f32 v115, v115, v123
    v_cvt_pk_bf16_f32 v27, v114, v115
    v_mul_f32 v116, v116, v124
    v_mul_f32 v117, v117, v125
    v_cvt_pk_bf16_f32 v30, v116, v117
    v_mul_f32 v118, v118, v126
    v_mul_f32 v119, v119, v127
    v_cvt_pk_bf16_f32 v31, v118, v119
    s_waitcnt vmcnt(0)
    v_mov_b32 v7, 2
    s_mov_b64 exec, 1
    buffer_store_dword v7, off, s[32:35], s57 sc1
    s_mov_b64 exec, -1
    buffer_store_dwordx4 v[24:27], v6, s[32:35], s62 offen offset:0 sc1
    buffer_store_dwordx4 v[28:31], v6, s[32:35], s62 offen offset:1024 sc1
    s_waitcnt vmcnt(0)
    v_mov_b32 v7, 3
    s_mov_b64 exec, 1
    buffer_store_dword v7, off, s[32:35], s57 sc1
    s_mov_b64 exec, -1
    s_branch L_final
L_codeend:
    s_endpgm
.section .rodata,"a"
.p2align 6
.amdhsa_kernel standalone__glu_gated_bilinear__prompt_kernel
  .amdhsa_next_free_vgpr 256
  .amdhsa_next_free_sgpr 102
  .amdhsa_accum_offset 256
  .amdhsa_group_segment_fixed_size 0
  .amdhsa_kernarg_size 56
  .amdhsa_user_sgpr_count 2
  .amdhsa_user_sgpr_kernarg_segment_ptr 1
  .amdhsa_system_sgpr_workgroup_id_x 1
  .amdhsa_float_denorm_mode_32 3
.end_amdhsa_kernel
```
